```python
import torch

def _softmax(x, axis=-1):
    return torch.softmax(x, dim=axis)
def _gelu(x):
    return torch.nn.functional.gelu(x, approximate="tanh")
def _silu(x):
    return torch.nn.functional.silu(x)
def _sigmoid(x):
    return torch.sigmoid(x)
def _layernorm(x, axis=-1, eps=1e-5):
    m = x.mean(dim=axis, keepdim=True)
    v = x.var(dim=axis, keepdim=True, unbiased=False)
    return (x - m) / torch.sqrt(v + eps)
def _scatter_add(tgt, idx, src, axis=0):
    return tgt.clone().index_add_(axis, idx, src)
def _segment_sum(src, seg, n):
    out = torch.zeros((n,) + src.shape[1:], dtype=src.dtype)
    return out.index_add_(0, seg, src)
def _pad(x, pw):
    flat = tuple(v for pair in reversed(pw) for v in pair)
    return torch.nn.functional.pad(x, flat)

kernel_name = 'concat_heads__spectral_gfnet__mha_block__prompt'

def setup_inputs():

    _w = (lambda a: (lambda t: t.to(torch.bfloat16) if t.is_floating_point() else t)(torch.as_tensor(a)))
    def _A_setup():
        B, S, D = 1, 2048, 448
        Df = D // 2 + 1
        return {
            "x": _w((lambda *s: torch.randn(*s, dtype=torch.bfloat16) * 0.05)(B, S, D)),
            "w_r": _w((lambda *s: torch.randn(*s, dtype=torch.bfloat16) * 6.4)(S, Df) * 0.02),
            "w_i": _w((lambda *s: torch.randn(*s, dtype=torch.bfloat16) * 6.4)(S, Df) * 0.02),
        }
    _A_in = _A_setup()

    def _B_setup():
        B, S, D, H = 1, 2048, 448, 16
        return {
            "x": _w((lambda *s: torch.randn(*s, dtype=torch.bfloat16) * 0.2)(B, S, D)),
            "wqkv": _w((lambda *s: torch.randn(*s, dtype=torch.bfloat16) * 0.2)(D, 3 * D)),
            "wo": _w((lambda *s: torch.randn(*s, dtype=torch.bfloat16) * 0.05)(D, D)),
        }
    _B_in = _B_setup()

    return {
        "A_x": _A_in["x"],
        "A_w_r": _A_in["w_r"],
        "A_w_i": _A_in["w_i"],
        "B_x": _B_in["x"],
        "B_wqkv": _B_in["wqkv"],
        "B_wo": _B_in["wo"],
    }

def reference(A_x, A_w_r, A_w_i, B_x, B_wqkv, B_wo):
    def _A_ref(x, w_r, w_i):
        B, S, D = x.shape
        X = (lambda x, axes=(-2,-1): torch.fft.rfft2(x.float(), dim=axes))(x, axes=(-2, -1))
        W = w_r + 1j * w_i
        X = X * W
        y = (lambda x, s, axes=(-2,-1): torch.fft.irfft2(x, s=s, dim=axes).to(torch.bfloat16))(X, (S, D), axes=(-2, -1))
        return y

    def _B_ref(x, wqkv, wo):
        B, S, D = x.shape
        H = 16
        Dh = D // H
        qkv = (lambda x, *d: x.permute(*d))((x @ wqkv).reshape(B, S, 3, H, Dh), 2, 0, 3, 1, 4)
        q, k, v = qkv[0], qkv[1], qkv[2]
        scores = torch.einsum("bhqd,bhkd->bhqk", q, k) * (Dh ** -0.5)
        p = _softmax(scores, axis=-1)
        o = torch.einsum("bhqk,bhkd->bhqd", p, v)
        return (lambda x, *d: x.permute(*d))(o, 0, 2, 1, 3).reshape(B, S, D) @ wo

    a = _A_ref(A_x, A_w_r, A_w_i)
    b = _B_ref(B_x, B_wqkv, B_wo)
    return torch.concatenate([a, b], axis=-1)
```

```asm
; @launch grid=(256,1,1) block=(512,1,1) lds=163840
.amdgcn_target "amdgcn-amd-amdhsa--gfx950"
.text
.globl concat_heads__spectral_gfnet__mha_block__prompt_kernel
.p2align 8
.type concat_heads__spectral_gfnet__mha_block__prompt_kernel,@function
concat_heads__spectral_gfnet__mha_block__prompt_kernel:
    s_load_dwordx2 s[20:21], s[0:1], 24
    s_load_dwordx2 s[24:25], s[0:1], 32
    s_getpc_b64 s[60:61]
K_PC:
    v_lshlrev_b32 v1, 7, v0
    s_bfe_u32 s62, s2, 196611
    s_mul_i32 s62, s62, 3840
    v_add_u32 v1, s62, v1
    v_cmpx_gt_u32 vcc, 30, v0
    global_load_dword v63, v1, s[60:61]
    s_mov_b64 exec, -1
    s_cmp_ge_u32 s2, 256
    s_cbranch_scc1 K_end_1
    v_lshrrev_b32 v1, 6, v0
    v_and_b32 v0, 63, v0
    v_readfirstlane_b32 s3, v1
    s_mov_b32 s22, 1835008
    s_mov_b32 s23, 0x00020000
    s_mov_b32 s26, 1204224
    s_mov_b32 s27, 0x00020000
    s_and_b32 s60, s2, 7
    s_lshr_b32 s61, s2, 3
    s_lshr_b32 s40, s60, 2
    s_lshl_b32 s40, s40, 3
    s_lshr_b32 s62, s61, 2
    s_add_u32 s40, s40, s62
    s_and_b32 s41, s60, 3
    s_lshl_b32 s41, s41, 2
    s_and_b32 s62, s61, 3
    s_add_u32 s41, s41, s62
    s_mov_b32 s43, s41
    s_cmp_lt_u32 s3, 4
    s_cbranch_scc1 K_comp_2
    s_setprio 3
    s_sub_u32 s65, s3, 4
    v_lshrrev_b32 v7, 3, v0
    v_mul_u32_u24 v8, 0x380, v7
    v_and_b32 v9, 7, v0
    v_lshrrev_b32 v10, 4, v0
    v_xor_b32 v11, v9, v10
    v_lshl_add_u32 v12, v11, 4, v8
    v_xor_b32 v11, 4, v11
    v_lshl_add_u32 v13, v11, 4, v8
    v_mul_u32_u24 v7, 37, v0
    v_lshrrev_b32 v7, 8, v7
    v_mul_u32_u24 v8, 7, v7
    v_sub_u32 v8, v0, v8
    v_and_b32 v9, 3, v7
    v_lshrrev_b32 v7, 2, v7
    v_lshl_add_u32 v7, v9, 2, v7
    v_mul_u32_u24 v7, 0xa80, v7
    v_lshl_add_u32 v14, v8, 4, v7
    s_lshl_b32 s66, s40, 7
    s_lshl_b32 s67, s65, 5
    s_add_u32 s66, s66, s67
    s_mul_i32 s66, s66, 896
    s_mul_i32 s67, s65, 43008
    s_mul_i32 s68, s43, 112
    s_add_u32 s67, s67, s68
    s_add_u32 s67, s67, 896
    s_lshl_b32 s68, s65, 12
    s_mul_i32 s69, s65, 1792
    s_bfe_u32 s70, s2, 131075
    s_lshr_b32 s71, s2, 5
    s_mul_i32 s70, s70, 2
    s_add_u32 s70, s70, s71
    s_sub_u32 s71, s70, 7
    s_min_u32 s70, s70, s71
    s_lshl_b32 s71, s70, 7
    s_add_u32 s66, s66, s71
    s_mul_i32 s71, s70, 172032
    s_add_u32 s67, s67, s71
    s_waitcnt lgkmcnt(0)
    s_add_u32 m0, s68, 116480
    s_add_u32 s72, s66, 0
    buffer_load_dwordx4 v12, s[20:23], s72 offen  lds
    s_add_u32 m0, s68, 117504
    s_add_u32 s72, s66, 7168
    buffer_load_dwordx4 v13, s[20:23], s72 offen  lds
    s_add_u32 m0, s68, 118528
    s_add_u32 s72, s66, 14336
    buffer_load_dwordx4 v12, s[20:23], s72 offen  lds
    s_add_u32 m0, s68, 119552
    s_add_u32 s72, s66, 21504
    buffer_load_dwordx4 v13, s[20:23], s72 offen  lds
    s_mov_b32 exec_hi, 0x00ffffff
    s_add_u32 m0, s69, 132864
    s_add_u32 s72, s67, 0
    buffer_load_dwordx4 v14, s[24:27], s72 offen  lds
    s_add_u32 m0, s69, 133760
    s_add_u32 s72, s67, 5376
    buffer_load_dwordx4 v14, s[24:27], s72 offen  lds
    s_mov_b32 exec_hi, -1
    s_add_u32 s70, s70, 1
    s_cmp_eq_u32 s70, 7
    s_cselect_b32 s70, 0, s70
    s_cselect_b32 s71, -6, 1
    s_lshl_b32 s72, s71, 7
    s_add_u32 s66, s66, s72
    s_mul_i32 s72, s71, 172032
    s_add_u32 s67, s67, s72
    s_load_dwordx2 s[4:5], s[0:1], 64
    s_load_dwordx2 s[8:9], s[0:1], 0
    s_load_dwordx2 s[12:13], s[0:1], 8
    s_load_dwordx2 s[16:17], s[0:1], 16
    s_load_dwordx2 s[28:29], s[0:1], 40
    s_load_dwordx2 s[32:33], s[0:1], 48
    s_load_dwordx2 s[36:37], s[0:1], 56
    s_mov_b32 s6, 17825792
    s_mov_b32 s7, 0x00020000
    s_mov_b32 s10, 1835008
    s_mov_b32 s11, 0x00020000
    s_mov_b32 s14, 921600
    s_mov_b32 s15, 0x00020000
    s_mov_b32 s18, 921600
    s_mov_b32 s19, 0x00020000
    s_mov_b32 s30, 401408
    s_mov_b32 s31, 0x00020000
    s_mov_b32 s34, 3670016
    s_mov_b32 s35, 0x00020000
    s_mov_b32 s38, 256
    s_mov_b32 s39, 0x00020000
    s_and_b32 s60, s2, 7
    s_lshr_b32 s61, s2, 3
    s_and_b32 s42, s3, 3
    s_lshl_b32 s44, s60, 5
    s_add_u32 s44, s44, s61
    s_lshl_b32 s48, s60, 3
    s_lshr_b32 s62, s61, 2
    s_add_u32 s48, s48, s62
    s_and_b32 s49, s61, 3
    v_lshrrev_b32 v7, 2, v0
    v_mul_u32_u24 v7, 0xa80, v7
    v_and_b32 v8, 3, v0
    v_lshl_add_u32 v15, v8, 4, v7
    s_mul_i32 s46, s43, 112
    s_mul_i32 s47, s41, 56
    s_sub_u32 s46, s46, s47
    s_add_u32 s46, s46, 896
    s_lshl_b32 s47, s65, 10
    s_add_u32 s72, s68, 69376
    v_and_b32 v5, 31, v0
    v_lshrrev_b32 v6, 5, v0
    v_bfe_u32 v7, v5, 1, 3
    v_lshlrev_b32 v4, 7, v5
    v_add_u32 v4, s72, v4
    v_add_u32 v3, 0, v6
    v_xor_b32 v3, v3, v7
    v_lshl_add_u32 v8, v3, 4, v4
    v_add_u32 v3, 2, v6
    v_xor_b32 v3, v3, v7
    v_lshl_add_u32 v9, v3, 4, v4
    v_add_u32 v3, 4, v6
    v_xor_b32 v3, v3, v7
    v_lshl_add_u32 v10, v3, 4, v4
    v_add_u32 v3, 6, v6
    v_xor_b32 v3, v3, v7
    v_lshl_add_u32 v11, v3, 4, v4
    v_mov_b32 v255, v8
    v_bfe_u32 v4, v0, 2, 2
    v_lshrrev_b32 v5, 5, v0
    v_lshl_add_u32 v4, v5, 3, v4
    v_lshlrev_b32 v4, 6, v4
    v_bfe_u32 v5, v0, 4, 1
    v_lshl_add_u32 v4, v5, 5, v4
    v_and_b32 v5, 3, v0
    v_lshl_add_u32 v4, v5, 3, v4
    v_add_u32 v249, 40704, v4
    v_lshlrev_b32 v1, 4, v0
    s_waitcnt lgkmcnt(0)
    s_lshl_b32 s50, s41, 18
    s_mov_b32 s64, s42
    s_lshl_b32 s65, s64, 14
    s_add_u32 s50, s50, s65
    s_mov_b32 s53, 15
    s_lshl_b32 s54, s42, 3
    s_mov_b32 s58, 0
    s_lshl_b32 s73, s49, 16
    s_add_u32 s73, s73, s65
    s_min_u32 s73, s73, 212992
    s_add_u32 s73, s73, 16842752
    s_mov_b64 s[80:81], s[4:5]
    s_mov_b32 s82, 0
    s_mov_b32 s83, 0x00020000
    s_mov_b32 s52, 0
    s_mov_b32 s55, 0
    s_lshl_b32 s56, s41, 4
    s_add_u32 s56, s56, s40
    s_lshl_b32 s56, s56, 7
    s_lshl_b32 s64, s64, 5
    s_add_u32 s56, s56, s64
    s_add_u32 s56, s56, 12582912
    v_lshrrev_b32 v2, 3, v0
    v_and_b32 v3, 31, v0
    v_add_lshl_u32 v216, v2, v3, 2
    v_mov_b32 v2, 0x40000000
    v_cmp_gt_u32 vcc, 4, v3
    s_nop 1
    v_cndmask_b32 v216, v2, v216, vcc
    v_add_u32 v218, 4096, v1
    v_add_u32 v219, 8192, v1
    v_add_u32 v220, 12288, v1
    v_mov_b32 v48, 0
    v_mov_b32 v49, 0
    v_mov_b32 v50, 0
    v_mov_b32 v51, 0
    v_mov_b32 v52, 0
    v_mov_b32 v53, 0
    v_mov_b32 v54, 0
    v_mov_b32 v55, 0
    v_mov_b32 v56, 0
    v_mov_b32 v57, 0
    v_mov_b32 v58, 0
    v_mov_b32 v59, 0
    v_mov_b32 v60, 0
    v_mov_b32 v61, 0
    v_mov_b32 v62, 0
    v_mov_b32 v63, 0
    v_mov_b32 v64, 0
    v_mov_b32 v65, 0
    v_mov_b32 v66, 0
    v_mov_b32 v67, 0
    v_mov_b32 v68, 0
    v_mov_b32 v69, 0
    v_mov_b32 v70, 0
    v_mov_b32 v71, 0
    v_mov_b32 v72, 0
    v_mov_b32 v73, 0
    v_mov_b32 v74, 0
    v_mov_b32 v75, 0
    v_mov_b32 v76, 0
    v_mov_b32 v77, 0
    v_mov_b32 v78, 0
    v_mov_b32 v79, 0
    v_mov_b32 v80, 0
    v_mov_b32 v81, 0
    v_mov_b32 v82, 0
    v_mov_b32 v83, 0
    v_mov_b32 v84, 0
    v_mov_b32 v85, 0
    v_mov_b32 v86, 0
    v_mov_b32 v87, 0
    v_mov_b32 v88, 0
    v_mov_b32 v89, 0
    v_mov_b32 v90, 0
    v_mov_b32 v91, 0
    v_mov_b32 v92, 0
    v_mov_b32 v93, 0
    v_mov_b32 v94, 0
    v_mov_b32 v95, 0
    v_mov_b32 v96, 0
    v_mov_b32 v97, 0
    v_mov_b32 v98, 0
    v_mov_b32 v99, 0
    v_mov_b32 v100, 0
    v_mov_b32 v101, 0
    v_mov_b32 v102, 0
    v_mov_b32 v103, 0
    v_mov_b32 v104, 0
    v_mov_b32 v105, 0
    v_mov_b32 v106, 0
    v_mov_b32 v107, 0
    v_mov_b32 v108, 0
    v_mov_b32 v109, 0
    v_mov_b32 v110, 0
    v_mov_b32 v111, 0
    v_mul_u32_u24 v3, 0x925, v0
    v_lshrrev_b32 v3, 15, v3
    v_mul_u32_u24 v5, 14, v3
    v_sub_u32 v5, v0, v5
    v_mul_u32_u24 v3, 0x380, v3
    v_lshl_add_u32 v254, v5, 4, v3
    s_mul_i32 s76, s49, 224
    s_lshl_b32 s76, s49, 8
    v_lshrrev_b32 v3, 4, v0
    v_lshlrev_b32 v5, 2, v3
    v_xor_b32 v5, v5, v0
    v_and_b32 v5, 15, v5
    v_mul_u32_u24 v3, 0x380, v3
    v_lshl_add_u32 v254, v5, 4, v3
    v_lshl_add_u32 v5, v5, 4, s76
    v_cmp_gt_u32 vcc, 0x380, v5
    v_mov_b32 v3, 0x40000000
    s_nop 0
    v_cndmask_b32 v254, v3, v254, vcc
    s_lshr_b32 s77, s2, 5
    s_lshl_b32 s77, s77, 1
    s_add_u32 s77, s77, s42
    v_mov_b32 v221, 0x40000000
    s_lshl_b32 s64, s42, 2
    s_add_u32 s64, s64, 163776
    v_mov_b32 v223, s64
    s_mul_i32 s64, s42, 6144
    v_add_u32 v10, s64, v1
    v_and_b32 v8, 31, v0
    v_lshlrev_b32 v8, 4, v8
    s_lshl_b32 s64, s42, 9
    v_add_u32 v8, s64, v8
    s_lshl_b32 s64, s40, 2
    s_add_u32 s64, s64, s42
    s_lshl_b32 s78, s64, 13
    s_lshl_b32 s64, s64, 4
    s_add_u32 s64, s64, s41
    s_lshl_b32 s64, s64, 11
    s_add_u32 s45, s64, 4194304
    s_lshl_b32 s64, s41, 6
    s_and_b32 s64, s64, 512
    s_and_b32 s65, s41, 7
    s_lshl2_add_u32 s64, s65, s64
    s_add_u32 s78, s78, s64
    s_add_u32 s78, s78, 13107200
    v_lshrrev_b32 v11, 2, v0
    v_lshlrev_b32 v11, 11, v11
    v_and_b32 v9, 3, v0
    v_lshl_add_u32 v11, v9, 4, v11
    s_mov_b32 s74, 0x3f80
    s_mov_b32 s75, 0x3f800000
    v_and_b32 v9, 31, v0
    v_lshlrev_b32 v9, 4, v9
    s_add_u32 s64, s42, 1
    s_and_b32 s64, s64, 3
    s_lshl_b32 s62, s64, 9
    s_mul_i32 s64, s64, 6144
    v_add_u32 v251, s62, v9
    v_add_u32 v5, s64, v1
    s_add_u32 s64, s42, 2
    s_and_b32 s64, s64, 3
    s_lshl_b32 s62, s64, 9
    s_mul_i32 s64, s64, 6144
    v_add_u32 v252, s62, v9
    v_add_u32 v6, s64, v1
    s_add_u32 s64, s42, 3
    s_and_b32 s64, s64, 3
    s_lshl_b32 s62, s64, 9
    s_mul_i32 s64, s64, 6144
    v_add_u32 v253, s62, v9
    v_add_u32 v7, s64, v1
    v_mov_b32 v250, 163712
    s_add_u32 m0, s68, 140032
    s_add_u32 s72, s66, 0
    buffer_load_dwordx4 v12, s[20:23], s72 offen  lds
    s_add_u32 m0, s68, 141056
    s_add_u32 s72, s66, 7168
    buffer_load_dwordx4 v13, s[20:23], s72 offen  lds
    s_add_u32 m0, s68, 142080
    s_add_u32 s72, s66, 14336
    buffer_load_dwordx4 v12, s[20:23], s72 offen  lds
    s_add_u32 m0, s68, 143104
    s_add_u32 s72, s66, 21504
    buffer_load_dwordx4 v13, s[20:23], s72 offen  lds
    s_mov_b32 exec_hi, 0x00ffffff
    s_add_u32 m0, s69, 156416
    s_add_u32 s72, s67, 0
    buffer_load_dwordx4 v14, s[24:27], s72 offen  lds
    s_add_u32 m0, s69, 157312
    s_add_u32 s72, s67, 5376
    buffer_load_dwordx4 v14, s[24:27], s72 offen  lds
    s_mov_b32 exec_hi, -1
    s_add_u32 s70, s70, 1
    s_cmp_eq_u32 s70, 7
    s_cselect_b32 s70, 0, s70
    s_cselect_b32 s71, -6, 1
    s_lshl_b32 s72, s71, 7
    s_add_u32 s66, s66, s72
    s_mul_i32 s72, s71, 172032
    s_add_u32 s67, s67, s72
    s_waitcnt vmcnt(6) lgkmcnt(0)
    s_barrier
    s_add_u32 m0, s68, 69376
    s_add_u32 s72, s66, 0
    buffer_load_dwordx4 v12, s[20:23], s72 offen  lds
    s_add_u32 m0, s68, 70400
    s_add_u32 s72, s66, 7168
    buffer_load_dwordx4 v13, s[20:23], s72 offen  lds
    s_add_u32 m0, s68, 71424
    s_add_u32 s72, s66, 14336
    buffer_load_dwordx4 v12, s[20:23], s72 offen  lds
    s_add_u32 m0, s68, 72448
    s_add_u32 s72, s66, 21504
    buffer_load_dwordx4 v13, s[20:23], s72 offen  lds
    s_mov_b32 exec_hi, 0x00ffffff
    s_add_u32 m0, s69, 85760
    s_add_u32 s72, s67, 0
    buffer_load_dwordx4 v14, s[24:27], s72 offen  lds
    s_add_u32 m0, s69, 86656
    s_add_u32 s72, s67, 5376
    buffer_load_dwordx4 v14, s[24:27], s72 offen  lds
    s_mov_b32 exec_hi, -1
    s_add_u32 s70, s70, 1
    s_cmp_eq_u32 s70, 7
    s_cselect_b32 s70, 0, s70
    s_cselect_b32 s71, -6, 1
    s_lshl_b32 s72, s71, 7
    s_add_u32 s66, s66, s72
    s_mul_i32 s72, s71, 172032
    s_add_u32 s67, s67, s72
    ds_read_b128 v[152:155], v255 offset:47104
    v_xor_b32 v2, 32, v255
    ds_read_b128 v[156:159], v2 offset:47104
    v_xor_b32 v2, 64, v255
    ds_read_b128 v[160:163], v2 offset:47104
    v_xor_b32 v2, 96, v255
    ds_read_b128 v[164:167], v2 offset:47104
    s_waitcnt vmcnt(6) lgkmcnt(0)
    s_barrier
    s_add_u32 m0, s68, 92928
    s_add_u32 s72, s66, 0
    buffer_load_dwordx4 v12, s[20:23], s72 offen  lds
    s_add_u32 m0, s68, 93952
    s_add_u32 s72, s66, 7168
    buffer_load_dwordx4 v13, s[20:23], s72 offen  lds
    s_add_u32 m0, s68, 94976
    s_add_u32 s72, s66, 14336
    buffer_load_dwordx4 v12, s[20:23], s72 offen  lds
    s_add_u32 m0, s68, 96000
    s_add_u32 s72, s66, 21504
    buffer_load_dwordx4 v13, s[20:23], s72 offen  lds
    s_mov_b32 exec_hi, 0x00ffffff
    s_add_u32 m0, s69, 109312
    s_add_u32 s72, s67, 0
    buffer_load_dwordx4 v14, s[24:27], s72 offen  lds
    s_add_u32 m0, s69, 110208
    s_add_u32 s72, s67, 5376
    buffer_load_dwordx4 v14, s[24:27], s72 offen  lds
    s_mov_b32 exec_hi, -1
    s_add_u32 s70, s70, 1
    s_cmp_eq_u32 s70, 7
    s_cselect_b32 s70, 0, s70
    s_cselect_b32 s71, -6, 1
    s_lshl_b32 s72, s71, 7
    s_add_u32 s66, s66, s72
    s_mul_i32 s72, s71, 172032
    s_add_u32 s67, s67, s72
    v_add_u32 v3, 70656, v255
    ds_read_b128 v[168:171], v3
    v_xor_b32 v2, 32, v3
    ds_read_b128 v[172:175], v2
    v_xor_b32 v2, 64, v3
    ds_read_b128 v[176:179], v2
    v_xor_b32 v2, 96, v3
    ds_read_b128 v[180:183], v2
    s_waitcnt vmcnt(6) lgkmcnt(0)
    s_barrier
    s_add_u32 m0, s68, 116480
    s_add_u32 s72, s66, 0
    buffer_load_dwordx4 v12, s[20:23], s72 offen  lds
    s_add_u32 m0, s68, 117504
    s_add_u32 s72, s66, 7168
    buffer_load_dwordx4 v13, s[20:23], s72 offen  lds
    s_add_u32 m0, s68, 118528
    s_add_u32 s72, s66, 14336
    buffer_load_dwordx4 v12, s[20:23], s72 offen  lds
    s_add_u32 m0, s68, 119552
    s_add_u32 s72, s66, 21504
    buffer_load_dwordx4 v13, s[20:23], s72 offen  lds
    s_mov_b32 exec_hi, 0x00ffffff
    s_add_u32 m0, s69, 132864
    s_add_u32 s72, s67, 0
    buffer_load_dwordx4 v14, s[24:27], s72 offen  lds
    s_add_u32 m0, s69, 133760
    s_add_u32 s72, s67, 5376
    buffer_load_dwordx4 v14, s[24:27], s72 offen  lds
    s_mov_b32 exec_hi, -1
    s_add_u32 s70, s70, 1
    s_cmp_eq_u32 s70, 7
    s_cselect_b32 s70, 0, s70
    s_cselect_b32 s71, -6, 1
    s_lshl_b32 s72, s71, 7
    s_add_u32 s66, s66, s72
    s_mul_i32 s72, s71, 172032
    s_add_u32 s67, s67, s72
    ds_read_b128 v[184:187], v255 offset:0
    v_xor_b32 v2, 32, v255
    ds_read_b128 v[188:191], v2 offset:0
    v_xor_b32 v2, 64, v255
    ds_read_b128 v[192:195], v2 offset:0
    v_xor_b32 v2, 96, v255
    ds_read_b128 v[196:199], v2 offset:0
    s_waitcnt vmcnt(6) lgkmcnt(0)
    s_barrier
    s_add_u32 m0, s68, 140032
    s_add_u32 s72, s66, 0
    buffer_load_dwordx4 v12, s[20:23], s72 offen  lds
    s_add_u32 m0, s68, 141056
    s_add_u32 s72, s66, 7168
    buffer_load_dwordx4 v13, s[20:23], s72 offen  lds
    s_add_u32 m0, s68, 142080
    s_add_u32 s72, s66, 14336
    buffer_load_dwordx4 v12, s[20:23], s72 offen  lds
    s_add_u32 m0, s68, 143104
    s_add_u32 s72, s66, 21504
    buffer_load_dwordx4 v13, s[20:23], s72 offen  lds
    s_mov_b32 exec_hi, 0x00ffffff
    s_add_u32 m0, s69, 156416
    s_add_u32 s72, s67, 0
    buffer_load_dwordx4 v14, s[24:27], s72 offen  lds
    s_add_u32 m0, s69, 157312
    s_add_u32 s72, s67, 5376
    buffer_load_dwordx4 v14, s[24:27], s72 offen  lds
    s_mov_b32 exec_hi, -1
    s_add_u32 s70, s70, 1
    s_cmp_eq_u32 s70, 7
    s_cselect_b32 s70, 0, s70
    s_cselect_b32 s71, -6, 1
    s_lshl_b32 s72, s71, 7
    s_add_u32 s66, s66, s72
    s_mul_i32 s72, s71, 172032
    s_add_u32 s67, s67, s72
    ds_read_b128 v[200:203], v255 offset:23552
    v_xor_b32 v2, 32, v255
    ds_read_b128 v[204:207], v2 offset:23552
    v_xor_b32 v2, 64, v255
    ds_read_b128 v[208:211], v2 offset:23552
    v_xor_b32 v2, 96, v255
    ds_read_b128 v[212:215], v2 offset:23552
    s_waitcnt vmcnt(6) lgkmcnt(0)
    s_barrier
    s_add_u32 m0, s68, 69376
    s_add_u32 s72, s66, 0
    buffer_load_dwordx4 v12, s[20:23], s72 offen  lds
    s_add_u32 m0, s68, 70400
    s_add_u32 s72, s66, 7168
    buffer_load_dwordx4 v13, s[20:23], s72 offen  lds
    s_add_u32 m0, s68, 71424
    s_add_u32 s72, s66, 14336
    buffer_load_dwordx4 v12, s[20:23], s72 offen  lds
    s_add_u32 m0, s68, 72448
    s_add_u32 s72, s66, 21504
    buffer_load_dwordx4 v13, s[20:23], s72 offen  lds
    s_mov_b32 exec_hi, 0x00ffffff
    s_add_u32 m0, s69, 85760
    s_add_u32 s72, s67, 0
    buffer_load_dwordx4 v14, s[24:27], s72 offen  lds
    s_add_u32 m0, s69, 86656
    s_add_u32 s72, s67, 5376
    buffer_load_dwordx4 v14, s[24:27], s72 offen  lds
    s_mov_b32 exec_hi, -1
    s_add_u32 s70, s70, 1
    s_cmp_eq_u32 s70, 7
    s_cselect_b32 s70, 0, s70
    s_cselect_b32 s71, -6, 1
    s_lshl_b32 s72, s71, 7
    s_add_u32 s66, s66, s72
    s_mul_i32 s72, s71, 172032
    s_add_u32 s67, s67, s72
    v_mov_b32 v2, 0
    buffer_load_dword v248, v2, s[36:39], 0 offen sc1
    ds_read_b128 v[112:115], v255 offset:47104
    v_xor_b32 v2, 32, v255
    ds_read_b128 v[116:119], v2 offset:47104
    v_xor_b32 v2, 64, v255
    ds_read_b128 v[120:123], v2 offset:47104
    v_xor_b32 v2, 96, v255
    ds_read_b128 v[124:127], v2 offset:47104
    s_waitcnt vmcnt(7) lgkmcnt(0)
    s_barrier
    s_sub_u32 s67, s67, s46
    s_mov_b32 s69, s47
    s_add_u32 m0, s69, 40704
    s_nop 0
    buffer_load_dwordx4 v15, s[24:27], s67 offen  lds
    s_add_u32 s70, s70, 1
    s_cmp_eq_u32 s70, 7
    s_cselect_b32 s70, 0, s70
    s_cselect_b32 s71, -6, 1
    s_mul_i32 s72, s71, 172032
    s_add_u32 s67, s67, s72
    s_add_u32 m0, s69, 44800
    s_nop 0
    buffer_load_dwordx4 v15, s[24:27], s67 offen  lds
    s_add_u32 s70, s70, 1
    s_cmp_eq_u32 s70, 7
    s_cselect_b32 s70, 0, s70
    s_cselect_b32 s71, -6, 1
    s_mul_i32 s72, s71, 172032
    s_add_u32 s67, s67, s72
    s_add_u32 m0, s69, 48896
    s_nop 0
    buffer_load_dwordx4 v15, s[24:27], s67 offen  lds
    s_add_u32 s70, s70, 1
    s_cmp_eq_u32 s70, 7
    s_cselect_b32 s70, 0, s70
    s_cselect_b32 s71, -6, 1
    s_mul_i32 s72, s71, 172032
    s_add_u32 s67, s67, s72
    s_add_u32 m0, s69, 52992
    s_nop 0
    buffer_load_dwordx4 v15, s[24:27], s67 offen  lds
    s_add_u32 s70, s70, 1
    s_cmp_eq_u32 s70, 7
    s_cselect_b32 s70, 0, s70
    s_cselect_b32 s71, -6, 1
    s_mul_i32 s72, s71, 172032
    s_add_u32 s67, s67, s72
    v_add_u32 v3, 70656, v255
    ds_read_b128 v[128:131], v3
    v_xor_b32 v2, 32, v3
    ds_read_b128 v[132:135], v2
    v_xor_b32 v2, 64, v3
    ds_read_b128 v[136:139], v2
    v_xor_b32 v2, 96, v3
    ds_read_b128 v[140:143], v2
    s_waitcnt vmcnt(5) lgkmcnt(0)
    s_barrier
    s_add_u32 m0, s69, 57088
    s_nop 0
    buffer_load_dwordx4 v15, s[24:27], s67 offen  lds
    s_add_u32 s70, s70, 1
    s_cmp_eq_u32 s70, 7
    s_cselect_b32 s70, 0, s70
    s_cselect_b32 s71, -6, 1
    s_mul_i32 s72, s71, 172032
    s_add_u32 s67, s67, s72
    s_add_u32 m0, s69, 61184
    s_nop 0
    buffer_load_dwordx4 v15, s[24:27], s67 offen  lds
    s_add_u32 s70, s70, 1
    s_cmp_eq_u32 s70, 7
    s_cselect_b32 s70, 0, s70
    s_cselect_b32 s71, -6, 1
    s_mul_i32 s72, s71, 172032
    s_add_u32 s67, s67, s72
    s_add_u32 m0, s69, 65280
    s_nop 0
    buffer_load_dwordx4 v15, s[24:27], s67 offen  lds
    s_add_u32 s70, s70, 1
    s_cmp_eq_u32 s70, 7
    s_cselect_b32 s70, 0, s70
    s_cselect_b32 s71, -6, 1
    s_mul_i32 s72, s71, 172032
    s_add_u32 s67, s67, s72
    s_setprio 2
    ds_read_b128 v[144:147], v255 offset:0
    v_xor_b32 v2, 32, v255
    ds_read_b128 v[148:151], v2 offset:0
    v_xor_b32 v2, 64, v255
    ds_read_b128 v[224:227], v2 offset:0
    v_xor_b32 v2, 96, v255
    ds_read_b128 v[228:231], v2 offset:0
    s_waitcnt vmcnt(3)
    v_mov_b32 v2, 163744
    v_mov_b32 v3, 1
    s_mov_b64 exec, 1
    ds_add_u32 v2, v3
    s_mov_b64 exec, -1
    v_mov_b32 v2, 163744
    s_mov_b32 s62, 1048576
CS_6:
    ds_read_b32 v3, v2
    s_waitcnt lgkmcnt(0)
    v_cmp_gt_u32 vcc, 4, v3
    s_sub_u32 s62, s62, 1
    s_cselect_b64 vcc, 0, vcc
    s_cbranch_vccnz CS_6
    ds_read_b64_tr_b16 v[16:17], v249 offset:0
    ds_read_b64_tr_b16 v[18:19], v249 offset:256
    ds_read_b64_tr_b16 v[20:21], v249 offset:1024
    ds_read_b64_tr_b16 v[22:23], v249 offset:1280
    ds_read_b64_tr_b16 v[24:25], v249 offset:2048
    ds_read_b64_tr_b16 v[26:27], v249 offset:2304
    ds_read_b64_tr_b16 v[28:29], v249 offset:3072
    ds_read_b64_tr_b16 v[30:31], v249 offset:3328
    ds_read_b64_tr_b16 v[32:33], v249 offset:4096
    ds_read_b64_tr_b16 v[34:35], v249 offset:4352
    ds_read_b64_tr_b16 v[36:37], v249 offset:5120
    ds_read_b64_tr_b16 v[38:39], v249 offset:5376
    s_waitcnt lgkmcnt(10)
    v_mfma_f32_32x32x16_bf16 v[232:247], v[16:19], v[152:155], 0
    ds_read_b64_tr_b16 v[40:41], v249 offset:6144
    ds_read_b64_tr_b16 v[42:43], v249 offset:6400
    s_waitcnt lgkmcnt(10)
    v_mfma_f32_32x32x16_bf16 v[232:247], v[20:23], v[156:159], v[232:247]
    ds_read_b64_tr_b16 v[44:45], v249 offset:7168
    ds_read_b64_tr_b16 v[46:47], v249 offset:7424
    s_waitcnt lgkmcnt(10)
    v_mfma_f32_32x32x16_bf16 v[232:247], v[24:27], v[160:163], v[232:247]
    ds_read_b64_tr_b16 v[16:17], v249 offset:8192
    ds_read_b64_tr_b16 v[18:19], v249 offset:8448
    s_waitcnt lgkmcnt(10)
    v_mfma_f32_32x32x16_bf16 v[232:247], v[28:31], v[164:167], v[232:247]
    ds_read_b64_tr_b16 v[20:21], v249 offset:9216
    ds_read_b64_tr_b16 v[22:23], v249 offset:9472
    s_waitcnt lgkmcnt(10)
    v_mfma_f32_32x32x16_bf16 v[232:247], v[32:35], v[168:171], v[232:247]
    ds_read_b64_tr_b16 v[24:25], v249 offset:10240
    ds_read_b64_tr_b16 v[26:27], v249 offset:10496
    s_waitcnt lgkmcnt(10)
    v_mfma_f32_32x32x16_bf16 v[232:247], v[36:39], v[172:175], v[232:247]
    ds_read_b64_tr_b16 v[28:29], v249 offset:11264
    ds_read_b64_tr_b16 v[30:31], v249 offset:11520
    s_waitcnt lgkmcnt(10)
    v_mfma_f32_32x32x16_bf16 v[232:247], v[40:43], v[176:179], v[232:247]
    ds_read_b64_tr_b16 v[32:33], v249 offset:12288
    ds_read_b64_tr_b16 v[34:35], v249 offset:12544
    s_waitcnt lgkmcnt(10)
    v_mfma_f32_32x32x16_bf16 v[232:247], v[44:47], v[180:183], v[232:247]
    ds_read_b64_tr_b16 v[36:37], v249 offset:13312
    ds_read_b64_tr_b16 v[38:39], v249 offset:13568
    s_waitcnt lgkmcnt(10)
    v_mfma_f32_32x32x16_bf16 v[232:247], v[16:19], v[184:187], v[232:247]
    ds_read_b64_tr_b16 v[40:41], v249 offset:14336
    ds_read_b64_tr_b16 v[42:43], v249 offset:14592
    s_waitcnt lgkmcnt(10)
    v_mfma_f32_32x32x16_bf16 v[232:247], v[20:23], v[188:191], v[232:247]
    ds_read_b64_tr_b16 v[44:45], v249 offset:15360
    ds_read_b64_tr_b16 v[46:47], v249 offset:15616
    s_waitcnt lgkmcnt(10)
    v_mfma_f32_32x32x16_bf16 v[232:247], v[24:27], v[192:195], v[232:247]
    s_waitcnt lgkmcnt(8)
    v_mfma_f32_32x32x16_bf16 v[232:247], v[28:31], v[196:199], v[232:247]
    s_waitcnt lgkmcnt(6)
    v_mfma_f32_32x32x16_bf16 v[232:247], v[32:35], v[200:203], v[232:247]
    s_waitcnt lgkmcnt(4)
    v_mfma_f32_32x32x16_bf16 v[232:247], v[36:39], v[204:207], v[232:247]
    s_waitcnt lgkmcnt(2)
    v_mfma_f32_32x32x16_bf16 v[232:247], v[40:43], v[208:211], v[232:247]
    s_waitcnt lgkmcnt(0)
    v_mfma_f32_32x32x16_bf16 v[232:247], v[44:47], v[212:215], v[232:247]
    s_waitcnt vmcnt(0)
    v_mov_b32 v2, 163748
    v_mov_b32 v3, 1
    s_mov_b64 exec, 1
    ds_add_u32 v2, v3
    s_mov_b64 exec, -1
    s_mov_b32 s62, 65536
EP_8:
    v_readfirstlane_b32 s0, v248
    s_sub_u32 s62, s62, 1
    s_cselect_b32 s0, 1, s0
    s_cmp_lg_u32 s0, 0
    s_cbranch_scc1 EP_9
    s_mov_b32 s63, 6
EP_10:
    s_nop 15
    s_sub_u32 s63, s63, 1
    s_cbranch_scc0 EP_10
    v_mov_b32 v2, 0
    buffer_load_dword v248, v2, s[36:39], 0 offen sc1
    s_waitcnt vmcnt(0)
    s_branch EP_8
EP_9:
    v_mov_b32 v2, 163748
    s_mov_b32 s62, 1048576
CS_11:
    ds_read_b32 v3, v2
    s_waitcnt lgkmcnt(0)
    v_cmp_gt_u32 vcc, 4, v3
    s_sub_u32 s62, s62, 1
    s_cselect_b64 vcc, 0, vcc
    s_cbranch_vccnz CS_11
    s_setprio 3
    v_mov_b32 v13, 0
    buffer_atomic_or v13, v216, s[4:7], s56 offen sc0 sc1
    ds_read_b64_tr_b16 v[16:17], v249 offset:16384
    ds_read_b64_tr_b16 v[18:19], v249 offset:16640
    ds_read_b64_tr_b16 v[20:21], v249 offset:17408
    ds_read_b64_tr_b16 v[22:23], v249 offset:17664
    ds_read_b64_tr_b16 v[24:25], v249 offset:18432
    ds_read_b64_tr_b16 v[26:27], v249 offset:18688
    ds_read_b64_tr_b16 v[28:29], v249 offset:19456
    ds_read_b64_tr_b16 v[30:31], v249 offset:19712
    ds_read_b64_tr_b16 v[32:33], v249 offset:20480
    ds_read_b64_tr_b16 v[34:35], v249 offset:20736
    ds_read_b64_tr_b16 v[36:37], v249 offset:21504
    ds_read_b64_tr_b16 v[38:39], v249 offset:21760
    s_waitcnt lgkmcnt(10)
    v_mfma_f32_32x32x16_bf16 v[232:247], v[16:19], v[112:115], v[232:247]
    ds_read_b64_tr_b16 v[40:41], v249 offset:22528
    ds_read_b64_tr_b16 v[42:43], v249 offset:22784
    s_waitcnt lgkmcnt(10)
    v_mfma_f32_32x32x16_bf16 v[232:247], v[20:23], v[116:119], v[232:247]
    ds_read_b64_tr_b16 v[44:45], v249 offset:23552
    ds_read_b64_tr_b16 v[46:47], v249 offset:23808
    s_waitcnt lgkmcnt(10)
    v_mfma_f32_32x32x16_bf16 v[232:247], v[24:27], v[120:123], v[232:247]
    ds_read_b64_tr_b16 v[16:17], v249 offset:24576
    ds_read_b64_tr_b16 v[18:19], v249 offset:24832
    s_waitcnt lgkmcnt(10)
    v_mfma_f32_32x32x16_bf16 v[232:247], v[28:31], v[124:127], v[232:247]
    ds_read_b64_tr_b16 v[20:21], v249 offset:25600
    ds_read_b64_tr_b16 v[22:23], v249 offset:25856
    s_waitcnt lgkmcnt(10)
    v_mfma_f32_32x32x16_bf16 v[232:247], v[32:35], v[128:131], v[232:247]
    ds_read_b64_tr_b16 v[24:25], v249 offset:26624
    ds_read_b64_tr_b16 v[26:27], v249 offset:26880
    s_waitcnt lgkmcnt(10)
    v_mfma_f32_32x32x16_bf16 v[232:247], v[36:39], v[132:135], v[232:247]
    ds_read_b64_tr_b16 v[28:29], v249 offset:27648
    ds_read_b64_tr_b16 v[30:31], v249 offset:27904
    s_waitcnt lgkmcnt(10)
    v_mfma_f32_32x32x16_bf16 v[232:247], v[40:43], v[136:139], v[232:247]
    s_waitcnt lgkmcnt(8)
    v_mfma_f32_32x32x16_bf16 v[232:247], v[44:47], v[140:143], v[232:247]
    s_waitcnt lgkmcnt(6)
    v_mfma_f32_32x32x16_bf16 v[232:247], v[16:19], v[144:147], v[232:247]
    s_waitcnt lgkmcnt(4)
    v_mfma_f32_32x32x16_bf16 v[232:247], v[20:23], v[148:151], v[232:247]
    s_waitcnt lgkmcnt(2)
    v_mfma_f32_32x32x16_bf16 v[232:247], v[24:27], v[224:227], v[232:247]
    s_waitcnt lgkmcnt(0)
    v_mfma_f32_32x32x16_bf16 v[232:247], v[28:31], v[228:231], v[232:247]
    s_mov_b32 s72, 0x3e8b97f6
    v_lshlrev_b32 v14, 4, v0
    s_lshl_b32 s71, s42, 11
    s_add_u32 s71, s71, 40704
    v_add_u32 v9, s71, v14
    v_cmp_gt_u32 vcc, 32, v0
    s_nop 5
    v_mul_f32 v232, s72, v232
    v_mul_f32 v233, s72, v233
    v_mul_f32 v234, s72, v234
    v_mul_f32 v235, s72, v235
    v_mul_f32 v236, s72, v236
    v_mul_f32 v237, s72, v237
    v_mul_f32 v238, s72, v238
    v_mul_f32 v239, s72, v239
    v_mul_f32 v240, s72, v240
    v_mul_f32 v241, s72, v241
    v_mul_f32 v242, s72, v242
    v_mul_f32 v243, s72, v243
    v_mul_f32 v244, s72, v244
    v_mul_f32 v245, s72, v245
    v_mul_f32 v246, s72, v246
    v_mul_f32 v247, s72, v247
    v_cvt_pk_bf16_f32 v40, v232, v233
    v_cvt_pk_bf16_f32 v41, v234, v235
    v_cvt_pk_bf16_f32 v42, v236, v237
    v_cvt_pk_bf16_f32 v43, v238, v239
    v_cvt_pk_bf16_f32 v44, v240, v241
    v_cvt_pk_bf16_f32 v45, v242, v243
    v_cvt_pk_bf16_f32 v46, v244, v245
    v_cvt_pk_bf16_f32 v47, v246, v247
    v_cndmask_b32 v46, 0, v46, vcc
    v_cndmask_b32 v47, 0, v47, vcc
    ds_write_b128 v9, v[40:43]
    ds_write_b128 v9, v[44:47] offset:1024
    s_waitcnt lgkmcnt(0)
    v_mov_b32 v2, 163720
    v_mov_b32 v3, 1
    s_mov_b64 exec, 1
    ds_add_u32 v2, v3
    s_mov_b64 exec, -1
    v_add_u32 v217, 2560, v254
    v_add_u32 v4, 5120, v254
    v_add_u32 v12, 7680, v254
    v_mov_b32 v144, 0
    v_mov_b32 v145, 0
    v_mov_b32 v146, 0
    v_mov_b32 v147, 0
    v_mov_b32 v148, 0
    v_mov_b32 v149, 0
    v_mov_b32 v150, 0
    v_mov_b32 v151, 0
    v_mov_b32 v208, 0
    v_mov_b32 v209, 0
    v_mov_b32 v210, 0
    v_mov_b32 v211, 0
    v_mov_b32 v212, 0
    v_mov_b32 v213, 0
    v_mov_b32 v214, 0
    v_mov_b32 v215, 0
    v_mov_b32 v140, 0
    v_mov_b32 v141, 0
    v_mov_b32 v142, 0
    v_mov_b32 v143, 0
    v_mov_b32 v2, 163720
    s_mov_b32 s62, 1048576
CS_13:
    ds_read_b32 v3, v2
    s_waitcnt lgkmcnt(0)
    v_cmp_gt_u32 vcc, 4, v3
    s_sub_u32 s62, s62, 1
    s_cselect_b64 vcc, 0, vcc
    s_cbranch_vccnz CS_13
    s_add_u32 s64, s42, 1
    s_and_b32 s64, s64, 3
    s_lshl_b32 s64, s64, 11
    s_add_u32 s64, s64, 40704
    v_add_u32 v2, s64, v14
    ds_read_b128 v[16:19], v2
    ds_read_b128 v[20:23], v2 offset:1024
    s_add_u32 s64, s42, 2
    s_and_b32 s64, s64, 3
    s_lshl_b32 s64, s64, 11
    s_add_u32 s64, s64, 40704
    v_add_u32 v2, s64, v14
    ds_read_b128 v[24:27], v2
    ds_read_b128 v[28:31], v2 offset:1024
    s_add_u32 s64, s42, 3
    s_and_b32 s64, s64, 3
    s_lshl_b32 s64, s64, 11
    s_add_u32 s64, s64, 40704
    v_add_u32 v2, s64, v14
    ds_read_b128 v[32:35], v2
    ds_read_b128 v[36:39], v2 offset:1024
    v_mov_b32 v2, 163712
    s_mov_b32 s62, 1048576
CS_15:
    ds_read_b32 v3, v2
    s_waitcnt lgkmcnt(0)
    v_cmp_gt_u32 vcc, 4, v3
    s_sub_u32 s62, s62, 1
    s_cselect_b64 vcc, 0, vcc
    s_cbranch_vccnz CS_15
    s_mov_b32 s62, 65536
    s_and_b32 s64, s77, 15
    s_add_u32 s77, s77, 4
    s_lshl_b32 s59, s64, 12
    s_mul_i32 s64, s64, 14336
    s_add_u32 m0, s59, 63232
    s_add_u32 s67, s64, s76
    s_branch CLAIM_ck
AT_start:
    v_mov_b32 v13, 0
    buffer_atomic_or v13, v216, s[4:7], s56 offen sc0 sc1
CLAIM_ck:
    s_waitcnt vmcnt(0)
    v_cmp_eq_u32 vcc, s0, v13
    s_sub_u32 s62, s62, 1
    s_cselect_b64 vcc, -1, vcc
    s_and_b32 s61, vcc_lo, vcc_hi
    s_and_b32 s61, s61, s53
    s_cbranch_scc0 AT_start
CLAIM_ok:
    s_ff1_i32_b32 s63, s61
    s_lshl_b32 s51, s63, 16
    s_add_u32 s51, s51, s50
    s_bitset0_b32 s53, s63
    buffer_load_dwordx4 v[152:155], v14, s[4:7], s51 offen offset:0 sc1
    buffer_load_dwordx4 v[156:159], v14, s[4:7], s51 offen offset:1024 sc1
    v_mov_b32 v13, 0
    buffer_atomic_or v13, v216, s[4:7], s56 offen sc0 sc1
    buffer_load_dword v222, v221, s[4:7], 0 offen
    buffer_load_dwordx4 v[184:187], v219, s[4:7], s51 offen offset:0 sc1
    buffer_load_dwordx4 v[188:191], v219, s[4:7], s51 offen offset:1024 sc1
    buffer_load_dword v222, v221, s[4:7], 0 offen
    buffer_load_dwordx4 v[160:163], v14, s[4:7], s51 offen offset:2048 sc1
    buffer_load_dwordx4 v[164:167], v14, s[4:7], s51 offen offset:3072 sc1
AT_pre2:
    s_setprio 1
    s_waitcnt vmcnt(7)
    s_waitcnt lgkmcnt(0)
    v_mfma_f32_32x32x16_bf16 v[112:127], v[152:155], v[16:19], 0
    v_mfma_f32_32x32x16_bf16 v[112:127], v[156:159], v[20:23], v[112:127]
    buffer_load_dword v222, v221, s[4:7], 0 offen
    buffer_load_dwordx4 v[192:195], v219, s[4:7], s51 offen offset:2048 sc1
    buffer_load_dwordx4 v[196:199], v219, s[4:7], s51 offen offset:3072 sc1
    buffer_load_dword v222, v221, s[4:7], 0 offen
    buffer_load_dwordx4 v[168:171], v218, s[4:7], s51 offen offset:0 sc1
    buffer_load_dwordx4 v[172:175], v218, s[4:7], s51 offen offset:1024 sc1
    buffer_load_dwordx4 v[200:203], v220, s[4:7], s51 offen offset:0 sc1
    buffer_load_dwordx4 v[204:207], v220, s[4:7], s51 offen offset:1024 sc1
    buffer_load_dwordx4 v[176:179], v218, s[4:7], s51 offen offset:2048 sc1
    buffer_load_dwordx4 v[180:183], v218, s[4:7], s51 offen offset:3072 sc1
    s_nop 7
.p2align 6
AT_loop:
    v_exp_f32 v112, v112
    v_exp_f32 v113, v113
    v_exp_f32 v114, v114
    v_exp_f32 v115, v115
    v_cvt_pk_bf16_f32 v150, v140, v141
    v_cvt_pk_bf16_f32 v151, v142, v143
    v_mfma_f32_32x32x16_bf16 v[128:143], v[152:155], v[24:27], 0
    ds_write_b32 v223, v223
    v_exp_f32 v116, v116
    v_exp_f32 v117, v117
    v_exp_f32 v118, v118
    v_exp_f32 v119, v119
    v_cvt_pk_bf16_f32 v144, v112, v113
    v_cvt_pk_bf16_f32 v145, v114, v115
    v_mfma_f32_32x32x16_bf16 v[128:143], v[156:159], v[28:31], v[128:143]
    v_exp_f32 v120, v120
    v_exp_f32 v121, v121
    v_exp_f32 v122, v122
    v_exp_f32 v123, v123
    v_cvt_pk_bf16_f32 v146, v116, v117
    v_cvt_pk_bf16_f32 v147, v118, v119
    v_mfma_f32_32x32x16_bf16 v[96:111], v[212:215], v[148:151], v[96:111]
    s_waitcnt vmcnt(13)
    v_cmp_eq_u32 vcc, s0, v13
    v_exp_f32 v124, v124
    v_exp_f32 v125, v125
    v_exp_f32 v126, v126
    v_exp_f32 v127, v127
    v_cvt_pk_bf16_f32 v148, v120, v121
    v_cvt_pk_bf16_f32 v149, v122, v123
    v_mfma_f32_32x32x16_bf16 v[48:63], v[184:187], v[144:147], v[48:63]
    s_and_b32 s61, vcc_lo, vcc_hi
    v_exp_f32 v128, v128
    v_exp_f32 v129, v129
    v_exp_f32 v130, v130
    v_exp_f32 v131, v131
    v_cvt_pk_bf16_f32 v150, v124, v125
    v_cvt_pk_bf16_f32 v151, v126, v127
    v_mfma_f32_32x32x16_bf16 v[112:127], v[152:155], v[32:35], 0
    buffer_load_dwordx4 v[208:211], v220, s[4:7], s51 offen offset:2048 sc1
    v_exp_f32 v132, v132
    v_exp_f32 v133, v133
    v_exp_f32 v134, v134
    v_exp_f32 v135, v135
    v_cvt_pk_bf16_f32 v144, v128, v129
    v_cvt_pk_bf16_f32 v145, v130, v131
    v_mfma_f32_32x32x16_bf16 v[112:127], v[156:159], v[36:39], v[112:127]
    buffer_load_dwordx4 v[212:215], v220, s[4:7], s51 offen offset:3072 sc1
    v_exp_f32 v136, v136
    v_exp_f32 v137, v137
    v_exp_f32 v138, v138
    v_exp_f32 v139, v139
    v_cvt_pk_bf16_f32 v146, v132, v133
    v_cvt_pk_bf16_f32 v147, v134, v135
    v_mfma_f32_32x32x16_bf16 v[48:63], v[188:191], v[148:151], v[48:63]
    s_and_b32 s61, s61, s53
    v_exp_f32 v140, v140
    v_exp_f32 v141, v141
    v_exp_f32 v142, v142
    v_exp_f32 v143, v143
    v_cvt_pk_bf16_f32 v148, v136, v137
    v_cvt_pk_bf16_f32 v149, v138, v139
    v_mfma_f32_32x32x16_bf16 v[64:79], v[184:187], v[144:147], v[64:79]
    s_cselect_b32 s82, 17825792, s58
    v_exp_f32 v112, v112
    v_exp_f32 v113, v113
    v_exp_f32 v114, v114
    v_exp_f32 v115, v115
    v_cvt_pk_bf16_f32 v150, v140, v141
    v_cvt_pk_bf16_f32 v151, v142, v143
    v_mfma_f32_32x32x16_bf16 v[128:143], v[152:155], v[40:43], 0
    s_ff1_i32_b32 s63, s61
    v_exp_f32 v116, v116
    v_exp_f32 v117, v117
    v_exp_f32 v118, v118
    v_exp_f32 v119, v119
    v_cvt_pk_bf16_f32 v144, v112, v113
    v_cvt_pk_bf16_f32 v145, v114, v115
    v_mfma_f32_32x32x16_bf16 v[128:143], v[156:159], v[44:47], v[128:143]
    s_lshl_b32 s52, s63, 16
    v_exp_f32 v120, v120
    v_exp_f32 v121, v121
    v_exp_f32 v122, v122
    v_exp_f32 v123, v123
    v_cvt_pk_bf16_f32 v146, v116, v117
    v_cvt_pk_bf16_f32 v147, v118, v119
    v_mfma_f32_32x32x16_bf16 v[64:79], v[188:191], v[148:151], v[64:79]
    s_add_u32 s52, s52, s50
    v_exp_f32 v124, v124
    v_exp_f32 v125, v125
    v_exp_f32 v126, v126
    v_exp_f32 v127, v127
    v_cvt_pk_bf16_f32 v148, v120, v121
    v_cvt_pk_bf16_f32 v149, v122, v123
    v_mfma_f32_32x32x16_bf16 v[80:95], v[184:187], v[144:147], v[80:95]
    s_waitcnt vmcnt(12)
    v_exp_f32 v128, v128
    v_exp_f32 v129, v129
    v_exp_f32 v130, v130
    v_exp_f32 v131, v131
    v_cvt_pk_bf16_f32 v150, v124, v125
    v_cvt_pk_bf16_f32 v151, v126, v127
    v_mfma_f32_32x32x16_bf16 v[112:127], v[160:163], v[16:19], 0
    buffer_load_dwordx4 v[152:155], v14, s[80:83], s52 offen offset:0 sc1
    v_exp_f32 v132, v132
    v_exp_f32 v133, v133
    v_exp_f32 v134, v134
    v_exp_f32 v135, v135
    v_cvt_pk_bf16_f32 v144, v128, v129
    v_cvt_pk_bf16_f32 v145, v130, v131
    v_mfma_f32_32x32x16_bf16 v[112:127], v[164:167], v[20:23], v[112:127]
    buffer_load_dwordx4 v[156:159], v14, s[80:83], s52 offen offset:1024 sc1
    v_exp_f32 v136, v136
    v_exp_f32 v137, v137
    v_exp_f32 v138, v138
    v_exp_f32 v139, v139
    v_cvt_pk_bf16_f32 v146, v132, v133
    v_cvt_pk_bf16_f32 v147, v134, v135
    v_mfma_f32_32x32x16_bf16 v[80:95], v[188:191], v[148:151], v[80:95]
    s_bitset0_b32 s53, s63
    v_exp_f32 v140, v140
    v_exp_f32 v141, v141
    v_exp_f32 v142, v142
    v_exp_f32 v143, v143
    v_cvt_pk_bf16_f32 v148, v136, v137
    v_cvt_pk_bf16_f32 v149, v138, v139
    v_mov_b32 v13, 0
    v_mfma_f32_32x32x16_bf16 v[96:111], v[184:187], v[144:147], v[96:111]
    buffer_atomic_or v13, v216, s[4:7], s56 offen sc0 sc1
    v_exp_f32 v112, v112
    v_exp_f32 v113, v113
    v_exp_f32 v114, v114
    v_exp_f32 v115, v115
    v_cvt_pk_bf16_f32 v150, v140, v141
    v_cvt_pk_bf16_f32 v151, v142, v143
    v_mfma_f32_32x32x16_bf16 v[128:143], v[160:163], v[24:27], 0
    buffer_load_dwordx4 v254, s[28:31], s67 offen offset:0 lds
    v_exp_f32 v116, v116
    v_exp_f32 v117, v117
    v_exp_f32 v118, v118
    v_exp_f32 v119, v119
    v_cvt_pk_bf16_f32 v144, v112, v113
    v_cvt_pk_bf16_f32 v145, v114, v115
    v_mfma_f32_32x32x16_bf16 v[128:143], v[164:167], v[28:31], v[128:143]
    s_mov_b32 s51, s52
    v_exp_f32 v120, v120
    v_exp_f32 v121, v121
    v_exp_f32 v122, v122
    v_exp_f32 v123, v123
    v_cvt_pk_bf16_f32 v146, v116, v117
    v_cvt_pk_bf16_f32 v147, v118, v119
    v_mfma_f32_32x32x16_bf16 v[96:111], v[188:191], v[148:151], v[96:111]
    s_waitcnt vmcnt(13)
    v_exp_f32 v124, v124
    v_exp_f32 v125, v125
    v_exp_f32 v126, v126
    v_exp_f32 v127, v127
    v_cvt_pk_bf16_f32 v148, v120, v121
    v_cvt_pk_bf16_f32 v149, v122, v123
    v_mfma_f32_32x32x16_bf16 v[48:63], v[192:195], v[144:147], v[48:63]
    v_exp_f32 v128, v128
    v_exp_f32 v129, v129
    v_exp_f32 v130, v130
    v_exp_f32 v131, v131
    v_cvt_pk_bf16_f32 v150, v124, v125
    v_cvt_pk_bf16_f32 v151, v126, v127
    v_mfma_f32_32x32x16_bf16 v[112:127], v[160:163], v[32:35], 0
    buffer_load_dwordx4 v[184:187], v219, s[80:83], s52 offen offset:0 sc1
    v_exp_f32 v132, v132
    v_exp_f32 v133, v133
    v_exp_f32 v134, v134
    v_exp_f32 v135, v135
    v_cvt_pk_bf16_f32 v144, v128, v129
    v_cvt_pk_bf16_f32 v145, v130, v131
    v_mfma_f32_32x32x16_bf16 v[112:127], v[164:167], v[36:39], v[112:127]
    buffer_load_dwordx4 v[188:191], v219, s[80:83], s52 offen offset:1024 sc1
    v_exp_f32 v136, v136
    v_exp_f32 v137, v137
    v_exp_f32 v138, v138
    v_exp_f32 v139, v139
    v_cvt_pk_bf16_f32 v146, v132, v133
    v_cvt_pk_bf16_f32 v147, v134, v135
    v_mfma_f32_32x32x16_bf16 v[48:63], v[196:199], v[148:151], v[48:63]
    v_exp_f32 v140, v140
    v_exp_f32 v141, v141
    v_exp_f32 v142, v142
    v_exp_f32 v143, v143
    v_cvt_pk_bf16_f32 v148, v136, v137
    v_cvt_pk_bf16_f32 v149, v138, v139
    v_mfma_f32_32x32x16_bf16 v[64:79], v[192:195], v[144:147], v[64:79]
    v_exp_f32 v112, v112
    v_exp_f32 v113, v113
    v_exp_f32 v114, v114
    v_exp_f32 v115, v115
    v_cvt_pk_bf16_f32 v150, v140, v141
    v_cvt_pk_bf16_f32 v151, v142, v143
    v_mfma_f32_32x32x16_bf16 v[128:143], v[160:163], v[40:43], 0
    buffer_load_dwordx4 v217, s[28:31], s67 offen offset:1024 lds
    v_exp_f32 v116, v116
    v_exp_f32 v117, v117
    v_exp_f32 v118, v118
    v_exp_f32 v119, v119
    v_cvt_pk_bf16_f32 v144, v112, v113
    v_cvt_pk_bf16_f32 v145, v114, v115
    v_mfma_f32_32x32x16_bf16 v[128:143], v[164:167], v[44:47], v[128:143]
    v_exp_f32 v120, v120
    v_exp_f32 v121, v121
    v_exp_f32 v122, v122
    v_exp_f32 v123, v123
    v_cvt_pk_bf16_f32 v146, v116, v117
    v_cvt_pk_bf16_f32 v147, v118, v119
    v_mfma_f32_32x32x16_bf16 v[64:79], v[196:199], v[148:151], v[64:79]
    v_exp_f32 v124, v124
    v_exp_f32 v125, v125
    v_exp_f32 v126, v126
    v_exp_f32 v127, v127
    v_cvt_pk_bf16_f32 v148, v120, v121
    v_cvt_pk_bf16_f32 v149, v122, v123
    v_mfma_f32_32x32x16_bf16 v[80:95], v[192:195], v[144:147], v[80:95]
    s_waitcnt vmcnt(13)
    v_exp_f32 v128, v128
    v_exp_f32 v129, v129
    v_exp_f32 v130, v130
    v_exp_f32 v131, v131
    v_cvt_pk_bf16_f32 v150, v124, v125
    v_cvt_pk_bf16_f32 v151, v126, v127
    v_mfma_f32_32x32x16_bf16 v[112:127], v[168:171], v[16:19], 0
    buffer_load_dwordx4 v[160:163], v14, s[80:83], s52 offen offset:2048 sc1
    v_exp_f32 v132, v132
    v_exp_f32 v133, v133
    v_exp_f32 v134, v134
    v_exp_f32 v135, v135
    v_cvt_pk_bf16_f32 v144, v128, v129
    v_cvt_pk_bf16_f32 v145, v130, v131
    v_mfma_f32_32x32x16_bf16 v[112:127], v[172:175], v[20:23], v[112:127]
    buffer_load_dwordx4 v[164:167], v14, s[80:83], s52 offen offset:3072 sc1
    v_exp_f32 v136, v136
    v_exp_f32 v137, v137
    v_exp_f32 v138, v138
    v_exp_f32 v139, v139
    v_cvt_pk_bf16_f32 v146, v132, v133
    v_cvt_pk_bf16_f32 v147, v134, v135
    v_mfma_f32_32x32x16_bf16 v[80:95], v[196:199], v[148:151], v[80:95]
    v_exp_f32 v140, v140
    v_exp_f32 v141, v141
    v_exp_f32 v142, v142
    v_exp_f32 v143, v143
    v_cvt_pk_bf16_f32 v148, v136, v137
    v_cvt_pk_bf16_f32 v149, v138, v139
    v_mfma_f32_32x32x16_bf16 v[96:111], v[192:195], v[144:147], v[96:111]
    v_exp_f32 v112, v112
    v_exp_f32 v113, v113
    v_exp_f32 v114, v114
    v_exp_f32 v115, v115
    v_cvt_pk_bf16_f32 v150, v140, v141
    v_cvt_pk_bf16_f32 v151, v142, v143
    v_mfma_f32_32x32x16_bf16 v[128:143], v[168:171], v[24:27], 0
    buffer_load_dwordx4 v4, s[28:31], s67 offen offset:2048 lds
    v_exp_f32 v116, v116
    v_exp_f32 v117, v117
    v_exp_f32 v118, v118
    v_exp_f32 v119, v119
    v_cvt_pk_bf16_f32 v144, v112, v113
    v_cvt_pk_bf16_f32 v145, v114, v115
    v_mfma_f32_32x32x16_bf16 v[128:143], v[172:175], v[28:31], v[128:143]
    s_and_b32 s64, s77, 15
    v_exp_f32 v120, v120
    v_exp_f32 v121, v121
    v_exp_f32 v122, v122
    v_exp_f32 v123, v123
    v_cvt_pk_bf16_f32 v146, v116, v117
    v_cvt_pk_bf16_f32 v147, v118, v119
    v_mfma_f32_32x32x16_bf16 v[96:111], v[196:199], v[148:151], v[96:111]
    s_waitcnt vmcnt(14)
    v_exp_f32 v124, v124
    v_exp_f32 v125, v125
    v_exp_f32 v126, v126
    v_exp_f32 v127, v127
    v_cvt_pk_bf16_f32 v148, v120, v121
    v_cvt_pk_bf16_f32 v149, v122, v123
    v_mfma_f32_32x32x16_bf16 v[48:63], v[200:203], v[144:147], v[48:63]
    s_add_u32 s77, s77, 4
    v_exp_f32 v128, v128
    v_exp_f32 v129, v129
    v_exp_f32 v130, v130
    v_exp_f32 v131, v131
    v_cvt_pk_bf16_f32 v150, v124, v125
    v_cvt_pk_bf16_f32 v151, v126, v127
    v_mfma_f32_32x32x16_bf16 v[112:127], v[168:171], v[32:35], 0
    buffer_load_dwordx4 v[192:195], v219, s[80:83], s52 offen offset:2048 sc1
    v_exp_f32 v132, v132
    v_exp_f32 v133, v133
    v_exp_f32 v134, v134
    v_exp_f32 v135, v135
    v_cvt_pk_bf16_f32 v144, v128, v129
    v_cvt_pk_bf16_f32 v145, v130, v131
    v_mfma_f32_32x32x16_bf16 v[112:127], v[172:175], v[36:39], v[112:127]
    buffer_load_dwordx4 v[196:199], v219, s[80:83], s52 offen offset:3072 sc1
    v_exp_f32 v136, v136
    v_exp_f32 v137, v137
    v_exp_f32 v138, v138
    v_exp_f32 v139, v139
    v_cvt_pk_bf16_f32 v146, v132, v133
    v_cvt_pk_bf16_f32 v147, v134, v135
    v_mfma_f32_32x32x16_bf16 v[48:63], v[204:207], v[148:151], v[48:63]
    s_lshl_b32 s59, s64, 12
    v_exp_f32 v140, v140
    v_exp_f32 v141, v141
    v_exp_f32 v142, v142
    v_exp_f32 v143, v143
    v_cvt_pk_bf16_f32 v148, v136, v137
    v_cvt_pk_bf16_f32 v149, v138, v139
    v_mfma_f32_32x32x16_bf16 v[64:79], v[200:203], v[144:147], v[64:79]
    s_mul_i32 s64, s64, 14336
    v_exp_f32 v112, v112
    v_exp_f32 v113, v113
    v_exp_f32 v114, v114
    v_exp_f32 v115, v115
    v_cvt_pk_bf16_f32 v150, v140, v141
    v_cvt_pk_bf16_f32 v151, v142, v143
    v_mfma_f32_32x32x16_bf16 v[128:143], v[168:171], v[40:43], 0
    buffer_load_dwordx4 v12, s[28:31], s67 offen offset:3072 lds
    v_exp_f32 v116, v116
    v_exp_f32 v117, v117
    v_exp_f32 v118, v118
    v_exp_f32 v119, v119
    v_cvt_pk_bf16_f32 v144, v112, v113
    v_cvt_pk_bf16_f32 v145, v114, v115
    v_mfma_f32_32x32x16_bf16 v[128:143], v[172:175], v[44:47], v[128:143]
    v_exp_f32 v120, v120
    v_exp_f32 v121, v121
    v_exp_f32 v122, v122
    v_exp_f32 v123, v123
    v_cvt_pk_bf16_f32 v146, v116, v117
    v_cvt_pk_bf16_f32 v147, v118, v119
    v_mfma_f32_32x32x16_bf16 v[64:79], v[204:207], v[148:151], v[64:79]
    v_exp_f32 v124, v124
    v_exp_f32 v125, v125
    v_exp_f32 v126, v126
    v_exp_f32 v127, v127
    v_cvt_pk_bf16_f32 v148, v120, v121
    v_cvt_pk_bf16_f32 v149, v122, v123
    v_mfma_f32_32x32x16_bf16 v[80:95], v[200:203], v[144:147], v[80:95]
    s_waitcnt vmcnt(15)
    v_exp_f32 v128, v128
    v_exp_f32 v129, v129
    v_exp_f32 v130, v130
    v_exp_f32 v131, v131
    v_cvt_pk_bf16_f32 v150, v124, v125
    v_cvt_pk_bf16_f32 v151, v126, v127
    v_mfma_f32_32x32x16_bf16 v[112:127], v[176:179], v[16:19], 0
    buffer_load_dwordx4 v[168:171], v218, s[80:83], s52 offen offset:0 sc1
    v_exp_f32 v132, v132
    v_exp_f32 v133, v133
    v_exp_f32 v134, v134
    v_exp_f32 v135, v135
    v_cvt_pk_bf16_f32 v144, v128, v129
    v_cvt_pk_bf16_f32 v145, v130, v131
    v_mfma_f32_32x32x16_bf16 v[112:127], v[180:183], v[20:23], v[112:127]
    buffer_load_dwordx4 v[172:175], v218, s[80:83], s52 offen offset:1024 sc1
    v_exp_f32 v136, v136
    v_exp_f32 v137, v137
    v_exp_f32 v138, v138
    v_exp_f32 v139, v139
    v_cvt_pk_bf16_f32 v146, v132, v133
    v_cvt_pk_bf16_f32 v147, v134, v135
    v_mfma_f32_32x32x16_bf16 v[80:95], v[204:207], v[148:151], v[80:95]
    v_exp_f32 v140, v140
    v_exp_f32 v141, v141
    v_exp_f32 v142, v142
    v_exp_f32 v143, v143
    v_cvt_pk_bf16_f32 v148, v136, v137
    v_cvt_pk_bf16_f32 v149, v138, v139
    v_mfma_f32_32x32x16_bf16 v[96:111], v[200:203], v[144:147], v[96:111]
    v_exp_f32 v112, v112
    v_exp_f32 v113, v113
    v_exp_f32 v114, v114
    v_exp_f32 v115, v115
    v_cvt_pk_bf16_f32 v150, v140, v141
    v_cvt_pk_bf16_f32 v151, v142, v143
    v_mfma_f32_32x32x16_bf16 v[128:143], v[176:179], v[24:27], 0
    v_exp_f32 v116, v116
    v_exp_f32 v117, v117
    v_exp_f32 v118, v118
    v_exp_f32 v119, v119
    v_cvt_pk_bf16_f32 v144, v112, v113
    v_cvt_pk_bf16_f32 v145, v114, v115
    v_mfma_f32_32x32x16_bf16 v[128:143], v[180:183], v[28:31], v[128:143]
    v_exp_f32 v120, v120
    v_exp_f32 v121, v121
    v_exp_f32 v122, v122
    v_exp_f32 v123, v123
    v_cvt_pk_bf16_f32 v146, v116, v117
    v_cvt_pk_bf16_f32 v147, v118, v119
    v_mfma_f32_32x32x16_bf16 v[96:111], v[204:207], v[148:151], v[96:111]
    s_waitcnt vmcnt(15)
    v_exp_f32 v124, v124
    v_exp_f32 v125, v125
    v_exp_f32 v126, v126
    v_exp_f32 v127, v127
    v_cvt_pk_bf16_f32 v148, v120, v121
    v_cvt_pk_bf16_f32 v149, v122, v123
    v_mfma_f32_32x32x16_bf16 v[48:63], v[208:211], v[144:147], v[48:63]
    v_exp_f32 v128, v128
    v_exp_f32 v129, v129
    v_exp_f32 v130, v130
    v_exp_f32 v131, v131
    v_cvt_pk_bf16_f32 v150, v124, v125
    v_cvt_pk_bf16_f32 v151, v126, v127
    v_mfma_f32_32x32x16_bf16 v[112:127], v[176:179], v[32:35], 0
    buffer_load_dwordx4 v[200:203], v220, s[80:83], s52 offen offset:0 sc1
    v_exp_f32 v132, v132
    v_exp_f32 v133, v133
    v_exp_f32 v134, v134
    v_exp_f32 v135, v135
    v_cvt_pk_bf16_f32 v144, v128, v129
    v_cvt_pk_bf16_f32 v145, v130, v131
    v_mfma_f32_32x32x16_bf16 v[112:127], v[180:183], v[36:39], v[112:127]
    buffer_load_dwordx4 v[204:207], v220, s[80:83], s52 offen offset:1024 sc1
    v_exp_f32 v136, v136
    v_exp_f32 v137, v137
    v_exp_f32 v138, v138
    v_exp_f32 v139, v139
    v_cvt_pk_bf16_f32 v146, v132, v133
    v_cvt_pk_bf16_f32 v147, v134, v135
    v_mfma_f32_32x32x16_bf16 v[48:63], v[212:215], v[148:151], v[48:63]
    s_cmp_eq_u32 s53, 0
    v_exp_f32 v140, v140
    v_exp_f32 v141, v141
    v_exp_f32 v142, v142
    v_exp_f32 v143, v143
    v_cvt_pk_bf16_f32 v148, v136, v137
    v_cvt_pk_bf16_f32 v149, v138, v139
    v_mfma_f32_32x32x16_bf16 v[64:79], v[208:211], v[144:147], v[64:79]
    s_cselect_b32 s50, s73, s50
    v_exp_f32 v112, v112
    v_exp_f32 v113, v113
    v_exp_f32 v114, v114
    v_exp_f32 v115, v115
    v_cvt_pk_bf16_f32 v150, v140, v141
    v_cvt_pk_bf16_f32 v151, v142, v143
    v_mfma_f32_32x32x16_bf16 v[128:143], v[176:179], v[40:43], 0
    s_cselect_b32 s58, 17825792, 0
    v_exp_f32 v116, v116
    v_exp_f32 v117, v117
    v_exp_f32 v118, v118
    v_exp_f32 v119, v119
    v_cvt_pk_bf16_f32 v144, v112, v113
    v_cvt_pk_bf16_f32 v145, v114, v115
    v_mfma_f32_32x32x16_bf16 v[128:143], v[180:183], v[44:47], v[128:143]
    s_add_u32 m0, s59, 63232
    v_exp_f32 v120, v120
    v_exp_f32 v121, v121
    v_exp_f32 v122, v122
    v_exp_f32 v123, v123
    v_cvt_pk_bf16_f32 v146, v116, v117
    v_cvt_pk_bf16_f32 v147, v118, v119
    v_mfma_f32_32x32x16_bf16 v[64:79], v[212:215], v[148:151], v[64:79]
    s_add_u32 s67, s64, s76
    v_exp_f32 v124, v124
    v_exp_f32 v125, v125
    v_exp_f32 v126, v126
    v_exp_f32 v127, v127
    v_cvt_pk_bf16_f32 v148, v120, v121
    v_cvt_pk_bf16_f32 v149, v122, v123
    v_mfma_f32_32x32x16_bf16 v[80:95], v[208:211], v[144:147], v[80:95]
    s_waitcnt vmcnt(15)
    v_exp_f32 v128, v128
    v_exp_f32 v129, v129
    v_exp_f32 v130, v130
    v_exp_f32 v131, v131
    v_cvt_pk_bf16_f32 v150, v124, v125
    v_cvt_pk_bf16_f32 v151, v126, v127
    v_mfma_f32_32x32x16_bf16 v[112:127], v[152:155], v[16:19], 0
    buffer_load_dwordx4 v[176:179], v218, s[80:83], s52 offen offset:2048 sc1
    v_exp_f32 v132, v132
    v_exp_f32 v133, v133
    v_exp_f32 v134, v134
    v_exp_f32 v135, v135
    v_cvt_pk_bf16_f32 v144, v128, v129
    v_cvt_pk_bf16_f32 v145, v130, v131
    v_mfma_f32_32x32x16_bf16 v[112:127], v[156:159], v[20:23], v[112:127]
    buffer_load_dwordx4 v[180:183], v218, s[80:83], s52 offen offset:3072 sc1
    v_exp_f32 v136, v136
    v_exp_f32 v137, v137
    v_exp_f32 v138, v138
    v_exp_f32 v139, v139
    v_cvt_pk_bf16_f32 v146, v132, v133
    v_cvt_pk_bf16_f32 v147, v134, v135
    v_mfma_f32_32x32x16_bf16 v[80:95], v[212:215], v[148:151], v[80:95]
    s_cmp_lg_u32 s61, 0
    v_exp_f32 v140, v140
    v_exp_f32 v141, v141
    v_exp_f32 v142, v142
    v_exp_f32 v143, v143
    v_cvt_pk_bf16_f32 v148, v136, v137
    v_cvt_pk_bf16_f32 v149, v138, v139
    v_mfma_f32_32x32x16_bf16 v[96:111], v[208:211], v[144:147], v[96:111]
    s_cbranch_scc1 AT_loop
    s_cmp_lg_u32 s53, 0
    s_cbranch_scc1 AT_start
    s_setprio 3
    ds_read_b32 v3, v250 offset:4
    v_cvt_pk_bf16_f32 v150, v140, v141
    v_cvt_pk_bf16_f32 v151, v142, v143
    s_nop 1
    v_mfma_f32_32x32x16_bf16 v[96:111], v[212:215], v[148:151], v[96:111]
    v_cvt_pk_bf16_f32 v48, v48, v49
    v_cvt_pk_bf16_f32 v49, v50, v51
    v_cvt_pk_bf16_f32 v50, v52, v53
    v_cvt_pk_bf16_f32 v51, v54, v55
    v_cvt_pk_bf16_f32 v56, v56, v57
    v_cvt_pk_bf16_f32 v57, v58, v59
    v_cvt_pk_bf16_f32 v58, v60, v61
    v_cvt_pk_bf16_f32 v59, v62, v63
    s_waitcnt lgkmcnt(0)
    v_cmp_gt_u32 vcc, 4, v3
    s_cbranch_vccnz PW_17
PW_18:
    v_mov_b32 v3, 1
    ds_write_b32 v251, v55 offset:32768
    ds_write_b128 v5, v[48:51] offset:0
    ds_write_b128 v5, v[56:59] offset:1024
    v_cvt_pk_bf16_f32 v64, v64, v65
    v_cvt_pk_bf16_f32 v65, v66, v67
    v_cvt_pk_bf16_f32 v66, v68, v69
    v_cvt_pk_bf16_f32 v67, v70, v71
    v_cvt_pk_bf16_f32 v72, v72, v73
    v_cvt_pk_bf16_f32 v73, v74, v75
    v_cvt_pk_bf16_f32 v74, v76, v77
    v_cvt_pk_bf16_f32 v75, v78, v79
    ds_write_b32 v252, v71 offset:32772
    ds_write_b128 v6, v[64:67] offset:2048
    ds_write_b128 v6, v[72:75] offset:3072
    v_cvt_pk_bf16_f32 v80, v80, v81
    v_cvt_pk_bf16_f32 v81, v82, v83
    v_cvt_pk_bf16_f32 v82, v84, v85
    v_cvt_pk_bf16_f32 v83, v86, v87
    v_cvt_pk_bf16_f32 v88, v88, v89
    v_cvt_pk_bf16_f32 v89, v90, v91
    v_cvt_pk_bf16_f32 v90, v92, v93
    v_cvt_pk_bf16_f32 v91, v94, v95
    ds_write_b32 v253, v87 offset:32776
    ds_write_b128 v7, v[80:83] offset:4096
    ds_write_b128 v7, v[88:91] offset:5120
    s_mov_b64 exec, 1
    s_waitcnt vmcnt(6)
    ds_add_u32 v250, v3 offset:12
    s_mov_b64 exec, -1
    v_mov_b32 v4, s0
    v_mov_b32 v5, s0
    v_mov_b32 v6, s0
    v_mov_b32 v7, s0
    s_and_b32 s79, s0, 0x9fff
    s_or_b32 s79, s79, 0x2000
    s_lshl_b32 s79, s79, 16
    s_mov_b32 s62, 1048576
FN_19:
    ds_read_b32 v2, v250 offset:12
    ds_read_b128 v[136:139], v8 offset:32768
    ds_read_b128 v[112:115], v10 offset:0
    ds_read_b128 v[116:119], v10 offset:1024
    ds_read_b128 v[120:123], v10 offset:2048
    ds_read_b128 v[124:127], v10 offset:3072
    ds_read_b128 v[128:131], v10 offset:4096
    ds_read_b128 v[132:135], v10 offset:5120
    s_sub_u32 s62, s62, 1
    s_waitcnt lgkmcnt(7)
    v_cmp_gt_u32 vcc, 4, v2
    s_nop 0
    s_cselect_b64 vcc, 0, vcc
    s_cbranch_vccnz FN_19
    s_waitcnt lgkmcnt(5)
    v_add_f32 v136, v136, v103
    v_add_f32 v137, v137, v138
    v_add_f32 v9, v136, v137
    v_dot2_f32_bf16 v96, v112, s74, v96
    v_dot2_f32_bf16 v97, v112, s75, v97
    v_dot2_f32_bf16 v98, v113, s74, v98
    v_dot2_f32_bf16 v99, v113, s75, v99
    v_dot2_f32_bf16 v100, v114, s74, v100
    v_dot2_f32_bf16 v101, v114, s75, v101
    v_dot2_f32_bf16 v102, v115, s74, v102
    s_waitcnt lgkmcnt(4)
    v_dot2_f32_bf16 v104, v116, s74, v104
    v_dot2_f32_bf16 v105, v116, s75, v105
    v_dot2_f32_bf16 v106, v117, s74, v106
    v_dot2_f32_bf16 v107, v117, s75, v107
    v_dot2_f32_bf16 v108, v118, s74, v108
    v_dot2_f32_bf16 v109, v118, s75, v109
    v_dot2_f32_bf16 v110, v119, s74, v110
    s_waitcnt lgkmcnt(3)
    v_dot2_f32_bf16 v96, v120, s74, v96
    v_dot2_f32_bf16 v97, v120, s75, v97
    v_dot2_f32_bf16 v98, v121, s74, v98
    v_dot2_f32_bf16 v99, v121, s75, v99
    v_dot2_f32_bf16 v100, v122, s74, v100
    v_dot2_f32_bf16 v101, v122, s75, v101
    v_dot2_f32_bf16 v102, v123, s74, v102
    s_waitcnt lgkmcnt(2)
    v_dot2_f32_bf16 v104, v124, s74, v104
    v_dot2_f32_bf16 v105, v124, s75, v105
    v_dot2_f32_bf16 v106, v125, s74, v106
    v_dot2_f32_bf16 v107, v125, s75, v107
    v_dot2_f32_bf16 v108, v126, s74, v108
    v_dot2_f32_bf16 v109, v126, s75, v109
    v_dot2_f32_bf16 v110, v127, s74, v110
    s_waitcnt lgkmcnt(1)
    v_dot2_f32_bf16 v96, v128, s74, v96
    v_dot2_f32_bf16 v97, v128, s75, v97
    v_dot2_f32_bf16 v98, v129, s74, v98
    v_dot2_f32_bf16 v99, v129, s75, v99
    v_dot2_f32_bf16 v100, v130, s74, v100
    v_dot2_f32_bf16 v101, v130, s75, v101
    v_dot2_f32_bf16 v102, v131, s74, v102
    s_waitcnt lgkmcnt(0)
    s_mov_b64 exec, 1
    ds_add_u32 v250, v3 offset:28
    s_mov_b64 exec, -1
    v_dot2_f32_bf16 v104, v132, s74, v104
    v_dot2_f32_bf16 v105, v132, s75, v105
    v_dot2_f32_bf16 v106, v133, s74, v106
    v_dot2_f32_bf16 v107, v133, s75, v107
    v_dot2_f32_bf16 v108, v134, s74, v108
    v_dot2_f32_bf16 v109, v134, s75, v109
    v_dot2_f32_bf16 v110, v135, s74, v110
    v_cmp_nle_f32 s[76:77], 0.5, v9
    v_cmp_nge_f32 vcc, 0x5d800000, v9
    s_nop 0
    s_or_b64 s[76:77], s[76:77], vcc
    v_pk_add_f32 v[112:113], v[96:97], v[98:99]
    v_pk_add_f32 v[114:115], v[100:101], v[102:103]
    v_pk_add_f32 v[116:117], v[104:105], v[106:107]
    v_pk_add_f32 v[118:119], v[108:109], v[110:111]
    v_pk_add_f32 v[112:113], v[112:113], v[114:115]
    v_pk_add_f32 v[116:117], v[116:117], v[118:119]
    v_pk_add_f32 v[112:113], v[112:113], v[116:117]
    v_add_f32 v10, v112, v113
    s_movk_i32 s65, 0x207
    v_cmp_class_f32 vcc, v10, s65
    s_nop 0
    s_or_b64 s[76:77], s[76:77], vcc
    s_cbranch_scc1 K_slow_20
K_sret_21:
    v_rcp_f32 v2, v9
    v_rcp_f32 v3, v9
    s_nop 0
    v_pk_mul_f32 v[96:97], v[96:97], v[2:3]
    v_pk_mul_f32 v[98:99], v[98:99], v[2:3]
    v_pk_mul_f32 v[100:101], v[100:101], v[2:3]
    v_pk_mul_f32 v[102:103], v[102:103], v[2:3]
    v_cvt_pk_bf16_f32 v144, v96, v97
    v_cvt_pk_bf16_f32 v145, v98, v99
    v_cvt_pk_bf16_f32 v146, v100, v101
    v_cvt_pk_bf16_f32 v147, v102, s79
    buffer_store_dwordx4 v[144:147], v14, s[4:7], s45 offen offset:0 sc1
    v_pk_mul_f32 v[104:105], v[104:105], v[2:3]
    v_pk_mul_f32 v[106:107], v[106:107], v[2:3]
    v_pk_mul_f32 v[108:109], v[108:109], v[2:3]
    v_pk_mul_f32 v[110:111], v[110:111], v[2:3]
    v_cvt_pk_bf16_f32 v148, v104, v105
    v_cvt_pk_bf16_f32 v149, v106, v107
    v_cvt_pk_bf16_f32 v150, v108, v109
    v_cvt_pk_bf16_f32 v151, v110, s79
    buffer_store_dwordx4 v[148:151], v14, s[4:7], s45 offen offset:1024 sc1
    s_mov_b64 exec, 0x1111
    buffer_atomic_swap v4, v11, s[4:7], s78 offen sc1
    s_mov_b64 exec, -1
    s_setprio 0
    s_lshl_b32 s64, s0, 16
    s_bitset1_b32 s64, 31
    s_mov_b32 s62, 65536
    s_cmp_eq_u32 s82, 0
    s_cbranch_scc1 WD_fb
    s_waitcnt vmcnt(3)
WD_ret:
    v_xor_b32 v155, s64, v155
    v_xor_b32 v159, s64, v159
    v_xor_b32 v163, s64, v163
    v_xor_b32 v167, s64, v167
    v_xor_b32 v171, s64, v171
    v_xor_b32 v175, s64, v175
    v_xor_b32 v179, s64, v179
    v_xor_b32 v183, s64, v183
    v_xor_b32 v187, s64, v187
    v_xor_b32 v191, s64, v191
    v_xor_b32 v195, s64, v195
    v_xor_b32 v199, s64, v199
    v_xor_b32 v203, s64, v203
    v_xor_b32 v207, s64, v207
    v_or3_b32 v2, v155, v159, 0
    v_or3_b32 v2, v163, v167, v2
    v_or3_b32 v2, v171, v175, v2
    v_or3_b32 v2, v179, v183, v2
    v_or3_b32 v2, v187, v191, v2
    v_or3_b32 v2, v195, v199, v2
    v_or3_b32 v2, v203, v207, v2
    v_cmp_lt_u32 vcc, 0xffff, v2
    s_sub_u32 s62, s62, 1
    s_cselect_b64 vcc, 0, vcc
    s_cbranch_vccnz WD_fb
    v_lshrrev_b32 v2, 5, v0
    v_mul_u32_u24 v2, 7, v2
    v_bfe_u32 v3, v0, 2, 2
    v_add_u32 v4, v2, v3
    v_min_u32 v3, 2, v3
    v_add3_u32 v5, v2, v3, 4
    v_and_b32 v2, 1, v0
    v_lshlrev_b32 v2, 5, v2
    v_bfe_u32 v3, v0, 1, 1
    v_lshl_add_u32 v2, v3, 3, v2
    v_bfe_u32 v3, v0, 4, 1
    v_lshl_add_u32 v2, v3, 4, v2
    v_add_u32 v2, 63232, v2
    v_xor_b32 v3, s42, v4
    v_and_b32 v3, 3, v3
    v_lshl_add_u32 v3, v3, 6, v2
    v_lshl_add_u32 v16, v4, 8, v3
    v_xor_b32 v18, 0x80, v16
    v_xor_b32 v3, s42, v5
    v_and_b32 v3, 3, v3
    v_lshl_add_u32 v3, v3, 6, v2
    v_lshl_add_u32 v17, v5, 8, v3
    v_xor_b32 v19, 0x80, v17
    ds_read_b64_tr_b16 v[128:129], v16 offset:0
    ds_read_b64_tr_b16 v[130:131], v17 offset:0
    ds_read_b64_tr_b16 v[132:133], v18 offset:3584
    ds_read_b64_tr_b16 v[134:135], v19 offset:3584
    ds_read_b64_tr_b16 v[136:137], v16 offset:7168
    ds_read_b64_tr_b16 v[138:139], v17 offset:7168
    ds_read_b64_tr_b16 v[140:141], v18 offset:10752
    ds_read_b64_tr_b16 v[142:143], v19 offset:10752
    ds_read_b64_tr_b16 v[144:145], v16 offset:14336
    ds_read_b64_tr_b16 v[146:147], v17 offset:14336
    ds_read_b64_tr_b16 v[148:149], v18 offset:17920
    ds_read_b64_tr_b16 v[150:151], v19 offset:17920
    ds_read_b64_tr_b16 v[208:209], v16 offset:21504
    ds_read_b64_tr_b16 v[210:211], v17 offset:21504
    ds_read_b64_tr_b16 v[212:213], v18 offset:25088
    ds_read_b64_tr_b16 v[214:215], v19 offset:25088
    ds_read_b64_tr_b16 v[216:217], v16 offset:28672
    ds_read_b64_tr_b16 v[218:219], v17 offset:28672
    ds_read_b64_tr_b16 v[220:221], v18 offset:32256
    ds_read_b64_tr_b16 v[222:223], v19 offset:32256
    ds_read_b64_tr_b16 v[224:225], v16 offset:35840
    ds_read_b64_tr_b16 v[226:227], v17 offset:35840
    ds_read_b64_tr_b16 v[228:229], v18 offset:39424
    ds_read_b64_tr_b16 v[230:231], v19 offset:39424
    ds_read_b64_tr_b16 v[232:233], v16 offset:43008
    ds_read_b64_tr_b16 v[234:235], v17 offset:43008
    ds_read_b64_tr_b16 v[236:237], v18 offset:46592
    ds_read_b64_tr_b16 v[238:239], v19 offset:46592
    ds_read_b64_tr_b16 v[240:241], v16 offset:50176
    ds_read_b64_tr_b16 v[242:243], v17 offset:50176
    ds_read_b64_tr_b16 v[244:245], v18 offset:53760
    ds_read_b64_tr_b16 v[246:247], v19 offset:53760
    ds_read_b64_tr_b16 v[248:249], v16 offset:57344
    ds_read_b64_tr_b16 v[250:251], v17 offset:57344
    ds_read_b64_tr_b16 v[252:253], v18 offset:60928
    ds_read_b64_tr_b16 v[254:255], v19 offset:60928
    v_mov_b32 v96, 0
    v_mov_b32 v97, 0
    v_mov_b32 v98, 0
    v_mov_b32 v99, 0
    v_mov_b32 v100, 0
    v_mov_b32 v101, 0
    v_mov_b32 v102, 0
    v_mov_b32 v103, 0
    v_mov_b32 v104, 0
    v_mov_b32 v105, 0
    v_mov_b32 v106, 0
    v_mov_b32 v107, 0
    v_mov_b32 v108, 0
    v_mov_b32 v109, 0
    v_mov_b32 v110, 0
    v_mov_b32 v111, 0
    v_and_b32 v2, 31, v0
    v_mul_u32_u24 v2, 0xe0, v2
    v_and_b32 v3, 32, v0
    v_add_u32 v12, v2, v3
    s_mul_i32 s66, s48, 57344
    s_mul_i32 s65, s49, 224
    s_add_u32 s66, s66, s65
    s_mul_i32 s65, s42, 56
    s_lshl_b32 s76, s49, 8
    v_and_b32 v2, 31, v0
    v_xor_b32 v8, s42, v0
    v_and_b32 v8, 3, v8
    v_lshl_add_u32 v3, v8, 6, v3
    v_lshl_add_u32 v12, v2, 8, v3
    v_add_u32 v12, 131072, v12
    s_mul_i32 s66, s48, 57344
    s_add_u32 s66, s66, s76
    s_mul_i32 s65, s42, 14336
    v_lshrrev_b32 v3, 2, v0
    v_xor_b32 v8, s42, v3
    v_and_b32 v8, 3, v8
    v_lshlrev_b32 v8, 6, v8
    v_lshl_add_u32 v8, v3, 8, v8
    v_and_b32 v2, 3, v0
    v_lshl_add_u32 v8, v2, 4, v8
    v_add_u32 v8, 131072, v8
    v_mul_u32_u24 v9, 0x700, v3
    v_lshl_add_u32 v9, v2, 4, v9
    s_lshl_b32 s65, s42, 6
    s_add_u32 s68, s65, s76
    s_cmp_ge_u32 s68, 896
    s_cselect_b32 s65, 0x40000000, s65
    s_add_u32 s66, s66, s65
    s_add_u32 s66, s66, 896
    s_add_u32 s67, s66, 28672
    v_mov_b32 v2, 163792
    s_mov_b32 s64, 0xffff
    s_mov_b32 s65, 0
    s_mov_b32 s62, 1048576
    s_waitcnt lgkmcnt(0)
    v_and_b32 v131, s64, v131
    v_and_b32 v135, s64, v135
    v_and_b32 v139, s64, v139
    v_and_b32 v143, s64, v143
    v_and_b32 v147, s64, v147
    v_and_b32 v151, s64, v151
    v_and_b32 v211, s64, v211
    v_and_b32 v215, s64, v215
    v_and_b32 v219, s64, v219
    v_and_b32 v223, s64, v223
    v_and_b32 v227, s64, v227
    v_and_b32 v231, s64, v231
    v_and_b32 v235, s64, v235
    v_and_b32 v239, s64, v239
    v_and_b32 v243, s64, v243
    v_and_b32 v247, s64, v247
    v_and_b32 v251, s64, v251
    v_and_b32 v255, s64, v255
B3_23:
    s_setprio 0
B3_22:
    ds_read_b128 v[4:7], v2
    s_sub_u32 s62, s62, 1
    s_cselect_b32 s63, 15, 0
    s_waitcnt lgkmcnt(0)
    v_or3_b32 v4, v4, v5, v6
    v_or3_b32 v4, v4, v7, s63
    s_nop 0
    v_readfirstlane_b32 s64, v4
    s_nop 0
    s_andn2_b32 s64, s64, s65
    s_cbranch_scc0 B3_22
    s_setprio 2
    s_bitcmp1_b32 s64, 0
    s_cbranch_scc0 B3_24
    ds_read_b128 v[64:67], v14 offset:0
    ds_read_b128 v[68:71], v14 offset:1024
    ds_read_b128 v[72:75], v14 offset:2048
    ds_read_b128 v[76:79], v14 offset:3072
    ds_read_b128 v[80:83], v14 offset:4096
    ds_read_b128 v[84:87], v14 offset:5120
    ds_read_b128 v[88:91], v14 offset:6144
    ds_read_b128 v[92:95], v14 offset:7168
    s_waitcnt lgkmcnt(7)
    v_mfma_f32_32x32x16_bf16 v[96:111], v[128:131], v[64:67], v[96:111]
    s_waitcnt lgkmcnt(6)
    v_mfma_f32_32x32x16_bf16 v[96:111], v[132:135], v[68:71], v[96:111]
    s_waitcnt lgkmcnt(5)
    v_mfma_f32_32x32x16_bf16 v[96:111], v[136:139], v[72:75], v[96:111]
    s_waitcnt lgkmcnt(4)
    v_mfma_f32_32x32x16_bf16 v[96:111], v[140:143], v[76:79], v[96:111]
    s_waitcnt lgkmcnt(3)
    v_mfma_f32_32x32x16_bf16 v[96:111], v[144:147], v[80:83], v[96:111]
    s_waitcnt lgkmcnt(2)
    v_mfma_f32_32x32x16_bf16 v[96:111], v[148:151], v[84:87], v[96:111]
    s_waitcnt lgkmcnt(1)
    v_mfma_f32_32x32x16_bf16 v[96:111], v[208:211], v[88:91], v[96:111]
    s_waitcnt lgkmcnt(0)
    v_mfma_f32_32x32x16_bf16 v[96:111], v[212:215], v[92:95], v[96:111]
B3_24:
    s_bitcmp1_b32 s64, 1
    s_cbranch_scc0 B3_25
    ds_read_b128 v[64:67], v14 offset:8192
    ds_read_b128 v[68:71], v14 offset:9216
    ds_read_b128 v[72:75], v14 offset:10240
    ds_read_b128 v[76:79], v14 offset:11264
    ds_read_b128 v[80:83], v14 offset:12288
    ds_read_b128 v[84:87], v14 offset:13312
    ds_read_b128 v[88:91], v14 offset:14336
    ds_read_b128 v[92:95], v14 offset:15360
    s_waitcnt lgkmcnt(7)
    v_mfma_f32_32x32x16_bf16 v[96:111], v[216:219], v[64:67], v[96:111]
    s_waitcnt lgkmcnt(6)
    v_mfma_f32_32x32x16_bf16 v[96:111], v[220:223], v[68:71], v[96:111]
    s_waitcnt lgkmcnt(5)
    v_mfma_f32_32x32x16_bf16 v[96:111], v[224:227], v[72:75], v[96:111]
    s_waitcnt lgkmcnt(4)
    v_mfma_f32_32x32x16_bf16 v[96:111], v[228:231], v[76:79], v[96:111]
    s_waitcnt lgkmcnt(3)
    v_mfma_f32_32x32x16_bf16 v[96:111], v[232:235], v[80:83], v[96:111]
    s_waitcnt lgkmcnt(2)
    v_mfma_f32_32x32x16_bf16 v[96:111], v[236:239], v[84:87], v[96:111]
    s_waitcnt lgkmcnt(1)
    v_mfma_f32_32x32x16_bf16 v[96:111], v[240:243], v[88:91], v[96:111]
    s_waitcnt lgkmcnt(0)
    v_mfma_f32_32x32x16_bf16 v[96:111], v[244:247], v[92:95], v[96:111]
B3_25:
    s_bitcmp1_b32 s64, 2
    s_cbranch_scc0 B3_26
    ds_read_b128 v[64:67], v14 offset:16384
    ds_read_b128 v[68:71], v14 offset:17408
    ds_read_b128 v[72:75], v14 offset:18432
    ds_read_b128 v[76:79], v14 offset:19456
    ds_read_b128 v[80:83], v14 offset:20480
    ds_read_b128 v[84:87], v14 offset:21504
    ds_read_b128 v[88:91], v14 offset:22528
    ds_read_b128 v[92:95], v14 offset:23552
    s_waitcnt lgkmcnt(7)
    v_mfma_f32_32x32x16_bf16 v[96:111], v[248:251], v[64:67], v[96:111]
    s_waitcnt lgkmcnt(6)
    v_mfma_f32_32x32x16_bf16 v[96:111], v[252:255], v[68:71], v[96:111]
    s_waitcnt lgkmcnt(5)
    v_mfma_f32_32x32x16_bf16 v[96:111], v[152:155], v[72:75], v[96:111]
    s_waitcnt lgkmcnt(4)
    v_mfma_f32_32x32x16_bf16 v[96:111], v[156:159], v[76:79], v[96:111]
    s_waitcnt lgkmcnt(3)
    v_mfma_f32_32x32x16_bf16 v[96:111], v[160:163], v[80:83], v[96:111]
    s_waitcnt lgkmcnt(2)
    v_mfma_f32_32x32x16_bf16 v[96:111], v[164:167], v[84:87], v[96:111]
    s_waitcnt lgkmcnt(1)
    v_mfma_f32_32x32x16_bf16 v[96:111], v[168:171], v[88:91], v[96:111]
    s_waitcnt lgkmcnt(0)
    v_mfma_f32_32x32x16_bf16 v[96:111], v[172:175], v[92:95], v[96:111]
B3_26:
    s_bitcmp1_b32 s64, 3
    s_cbranch_scc0 B3_27
    ds_read_b128 v[64:67], v14 offset:24576
    ds_read_b128 v[68:71], v14 offset:25600
    ds_read_b128 v[72:75], v14 offset:26624
    ds_read_b128 v[76:79], v14 offset:27648
    ds_read_b128 v[80:83], v14 offset:28672
    ds_read_b128 v[84:87], v14 offset:29696
    ds_read_b128 v[88:91], v14 offset:30720
    ds_read_b128 v[92:95], v14 offset:31744
    s_waitcnt lgkmcnt(7)
    v_mfma_f32_32x32x16_bf16 v[96:111], v[176:179], v[64:67], v[96:111]
    s_waitcnt lgkmcnt(6)
    v_mfma_f32_32x32x16_bf16 v[96:111], v[180:183], v[68:71], v[96:111]
    s_waitcnt lgkmcnt(5)
    v_mfma_f32_32x32x16_bf16 v[96:111], v[184:187], v[72:75], v[96:111]
    s_waitcnt lgkmcnt(4)
    v_mfma_f32_32x32x16_bf16 v[96:111], v[188:191], v[76:79], v[96:111]
    s_waitcnt lgkmcnt(3)
    v_mfma_f32_32x32x16_bf16 v[96:111], v[192:195], v[80:83], v[96:111]
    s_waitcnt lgkmcnt(2)
    v_mfma_f32_32x32x16_bf16 v[96:111], v[196:199], v[84:87], v[96:111]
    s_waitcnt lgkmcnt(1)
    v_mfma_f32_32x32x16_bf16 v[96:111], v[200:203], v[88:91], v[96:111]
    s_waitcnt lgkmcnt(0)
    v_mfma_f32_32x32x16_bf16 v[96:111], v[204:207], v[92:95], v[96:111]
B3_27:
    s_or_b32 s65, s65, s64
    s_cmp_lg_u32 s65, 15
    s_cbranch_scc1 B3_23
    s_nop 8
    v_cvt_pk_bf16_f32 v20, v96, v97
    v_cvt_pk_bf16_f32 v21, v98, v99
    v_cvt_pk_bf16_f32 v22, v100, v101
    v_cvt_pk_bf16_f32 v23, v102, v103
    v_cvt_pk_bf16_f32 v24, v104, v105
    v_cvt_pk_bf16_f32 v25, v106, v107
    v_cvt_pk_bf16_f32 v26, v108, v109
    v_cvt_pk_bf16_f32 v27, v110, v111
    ds_write_b128 v12, v[20:23] offset:0
    ds_write_b128 v12, v[24:27] offset:16
    ds_read_b128 v[20:23], v8 offset:0
    ds_read_b128 v[24:27], v8 offset:4096
    s_waitcnt lgkmcnt(1)
    buffer_store_dwordx4 v[20:23], v9, s[32:35], s66 offen sc1
    s_waitcnt lgkmcnt(0)
    buffer_store_dwordx4 v[24:27], v9, s[32:35], s67 offen sc1
    s_endpgm
K_comp_2:
    s_load_dwordx2 s[4:5], s[0:1], 64
    s_load_dwordx2 s[8:9], s[0:1], 0
    s_load_dwordx2 s[12:13], s[0:1], 8
    s_load_dwordx2 s[16:17], s[0:1], 16
    s_load_dwordx2 s[28:29], s[0:1], 40
    s_load_dwordx2 s[32:33], s[0:1], 48
    s_load_dwordx2 s[36:37], s[0:1], 56
    s_mov_b32 s6, 17825792
    s_mov_b32 s7, 0x00020000
    s_mov_b32 s10, 1835008
    s_mov_b32 s11, 0x00020000
    s_mov_b32 s14, 921600
    s_mov_b32 s15, 0x00020000
    s_mov_b32 s18, 921600
    s_mov_b32 s19, 0x00020000
    s_mov_b32 s30, 401408
    s_mov_b32 s31, 0x00020000
    s_mov_b32 s34, 3670016
    s_mov_b32 s35, 0x00020000
    s_mov_b32 s38, 256
    s_mov_b32 s39, 0x00020000
    s_and_b32 s60, s2, 7
    s_lshr_b32 s61, s2, 3
    s_and_b32 s42, s3, 3
    s_lshl_b32 s44, s60, 5
    s_add_u32 s44, s44, s61
    s_lshl_b32 s48, s60, 3
    s_lshr_b32 s62, s61, 2
    s_add_u32 s48, s48, s62
    s_and_b32 s49, s61, 3
    v_mov_b32 v61, 0
    s_lshr_b32 s60, 1, s3
    s_bitcmp1_b32 s60, 0
    s_cbranch_scc0 K_sk_28
    v_mov_b32 v3, 0
    v_and_b32 v4, 31, v0
    v_lshlrev_b32 v4, 2, v4
    v_add_u32 v4, 163712, v4
    ds_write_b32 v4, v3
K_sk_28:
    v_mov_b32 v62, 0
    s_lshl_b32 s60, s2, 3
    s_add_u32 s60, s60, s3
    s_cmp_lg_u32 s60, 2
    s_cbranch_scc1 K_mk_29
    v_mov_b32 v2, 0
    s_mov_b32 s60, 15466496
    s_waitcnt lgkmcnt(0)
    buffer_load_dword v62, v2, s[4:7], s60 offen sc1
K_mk_29:
    s_waitcnt lgkmcnt(0)
    s_lshr_b32 s60, 1, s3
    s_bitcmp1_b32 s60, 0
    s_cbranch_scc0 K_sk_30
    s_mul_i32 s60, s2, 1664
    v_lshlrev_b32 v2, 7, v0
    v_cmp_lt_u32 vcc, 6, v0
    v_mov_b32 v3, 0x700
    s_nop 0
    v_cndmask_b32 v3, 0, v3, vcc
    v_add_u32 v3, v3, v2
    s_mul_i32 s61, s2, 5376
    s_mov_b64 exec, 8191
    buffer_load_dword v63, v2, s[28:31], s60 offen
    s_mov_b64 exec, 0x3fff
    buffer_load_dword v63, v3, s[24:27], s61 offen
    s_mov_b64 exec, -1
K_sk_30:
    s_lshr_b32 s60, 2, s3
    s_bitcmp1_b32 s60, 0
    s_cbranch_scc0 K_sk_31
    v_lshlrev_b32 v2, 9, v0
    s_lshl_b32 s60, s48, 2
    s_add_u32 s60, s60, s49
    s_lshl_b32 s60, s60, 11
    s_add_u32 s60, s60, 13107200
    v_mov_b32 v63, 0
    s_mov_b64 exec, 3
    buffer_atomic_or v63, v2, s[4:7], s60 offen sc1
    s_mov_b64 exec, -1
    s_lshl_b32 s60, s2, 10
    s_add_u32 s60, s60, 15728640
    v_mov_b32 v63, 0
    s_mov_b64 exec, 1
    buffer_atomic_or v63, v2, s[4:7], s60 offen sc1
    s_mov_b64 exec, -1
    s_lshl_b32 s60, s2, 6
    s_add_u32 s60, s60, 15990784
    s_cmp_lt_u32 s2, 16
    s_cselect_b32 s60, s60, 0x40000000
    v_mov_b32 v63, 0
    s_mov_b64 exec, 1
    buffer_atomic_or v63, v2, s[4:7], s60 offen sc1
    s_mov_b64 exec, -1
    s_lshl_b32 s60, s2, 10
    s_add_u32 s60, s60, 16252928
    v_mov_b32 v63, 0
    s_mov_b64 exec, 1
    buffer_atomic_or v63, v2, s[4:7], s60 offen sc1
    s_mov_b64 exec, -1
    s_lshl_b32 s60, s2, 6
    s_add_u32 s60, s60, 16515072
    s_cmp_lt_u32 s2, 16
    s_cselect_b32 s60, s60, 0x40000000
    v_mov_b32 v63, 0
    s_mov_b64 exec, 1
    buffer_atomic_or v63, v2, s[4:7], s60 offen sc1
    s_mov_b64 exec, -1
K_sk_31:
    s_lshr_b32 s60, 12, s3
    s_bitcmp1_b32 s60, 0
    s_cbranch_scc0 K_sk_32
    s_and_b32 s75, s3, 1
    s_mul_i32 s73, s75, 8194
    s_add_u32 s73, s73, 16416
    v_and_b32 v3, 31, v0
    v_lshrrev_b32 v9, 5, v0
    v_bfrev_b32 v8, 1
    v_mov_b32 v10, 0x200
    v_cmp_eq_u32 s[76:77], 0, v3
    v_add_u32 v2, 0, v9
    v_and_b32 v4, 3, v2
    v_cndmask_b32 v4, v2, v4, s[76:77]
    v_add_u32 v6, 63, v4
    v_sub_u32 v6, v6, v3
    v_mul_u32_u24 v7, 37, v6
    v_lshrrev_b32 v7, 8, v7
    v_mul_u32_u24 v7, 7, v7
    v_sub_u32 v6, v6, v7
    v_lshl_add_u32 v6, v6, 6, v3
    v_sub_u32 v7, 0x1c0, v6
    v_cmp_lt_u32 vcc, 0xe0, v6
    s_nop 1
    v_cndmask_b32 v6, v6, v7, vcc
    v_cndmask_b32 v7, 0, v10, vcc
    v_lshl_add_u32 v6, v6, 1, v7
    v_add_u32 v24, s73, v6
    v_cndmask_b32 v28, 0, v8, vcc
    v_add_u32 v2, 2, v9
    v_and_b32 v4, 3, v2
    v_cndmask_b32 v4, v2, v4, s[76:77]
    v_add_u32 v6, 63, v4
    v_sub_u32 v6, v6, v3
    v_mul_u32_u24 v7, 37, v6
    v_lshrrev_b32 v7, 8, v7
    v_mul_u32_u24 v7, 7, v7
    v_sub_u32 v6, v6, v7
    v_lshl_add_u32 v6, v6, 6, v3
    v_sub_u32 v7, 0x1c0, v6
    v_cmp_lt_u32 vcc, 0xe0, v6
    s_nop 1
    v_cndmask_b32 v6, v6, v7, vcc
    v_cndmask_b32 v7, 0, v10, vcc
    v_lshl_add_u32 v6, v6, 1, v7
    v_add_u32 v25, s73, v6
    v_cndmask_b32 v29, 0, v8, vcc
    v_add_u32 v2, 4, v9
    v_and_b32 v4, 3, v2
    v_cndmask_b32 v4, v2, v4, s[76:77]
    v_cndmask_b32 v5, v3, 32, s[76:77]
    v_add_u32 v6, 63, v4
    v_sub_u32 v6, v6, v5
    v_mul_u32_u24 v7, 37, v6
    v_lshrrev_b32 v7, 8, v7
    v_mul_u32_u24 v7, 7, v7
    v_sub_u32 v6, v6, v7
    v_lshl_add_u32 v6, v6, 6, v5
    v_sub_u32 v7, 0x1c0, v6
    v_cmp_lt_u32 vcc, 0xe0, v6
    s_nop 1
    v_cndmask_b32 v6, v6, v7, vcc
    v_cndmask_b32 v7, 0, v10, vcc
    v_lshl_add_u32 v6, v6, 1, v7
    v_add_u32 v26, s73, v6
    v_cndmask_b32 v30, 0, v8, vcc
    v_add_u32 v2, 6, v9
    v_and_b32 v4, 3, v2
    v_cndmask_b32 v4, v2, v4, s[76:77]
    v_cndmask_b32 v5, v3, 32, s[76:77]
    v_add_u32 v6, 63, v4
    v_sub_u32 v6, v6, v5
    v_mul_u32_u24 v7, 37, v6
    v_lshrrev_b32 v7, 8, v7
    v_mul_u32_u24 v7, 7, v7
    v_sub_u32 v6, v6, v7
    v_lshl_add_u32 v6, v6, 6, v5
    v_sub_u32 v7, 0x1c0, v6
    v_cmp_lt_u32 vcc, 0xe0, v6
    s_nop 1
    v_cndmask_b32 v6, v6, v7, vcc
    v_cndmask_b32 v7, 0, v10, vcc
    v_lshl_add_u32 v6, v6, 1, v7
    v_add_u32 v27, s73, v6
    v_cndmask_b32 v31, 0, v8, vcc
    s_and_b32 s75, s3, 1
    s_lshl_b32 s75, s75, 11
    v_lshlrev_b32 v2, 4, v0
    v_add_u32 v2, s75, v2
    ds_write_b128 v2, v[24:27] offset:33024
    ds_write_b128 v2, v[28:31] offset:34048
    s_lshl_b32 s60, s2, 3
    s_add_u32 s60, s60, s3
    s_cmp_lg_u32 s60, 2
    s_cbranch_scc1 K_mk_33
    s_waitcnt vmcnt(0)
    v_add_u32 v62, 1, v62
    v_max_u32 v62, 1, v62
    v_lshlrev_b32 v2, 2, v0
    s_mov_b32 s60, 15466496
    s_mov_b64 exec, 0xffff
    buffer_store_dword v62, v2, s[36:39], 0 offen sc1
    buffer_store_dword v62, v2, s[4:7], s60 offen sc1
    s_mov_b64 exec, -1
K_mk_33:
K_sk_32:
    s_waitcnt lgkmcnt(0)
    s_and_b32 s60, s2, 7
    s_lshr_b32 s61, s2, 3
    s_and_b32 s69, s60, 3
    s_lshr_b32 s70, s60, 2
    s_cmp_eq_u32 s61, 0
    s_cselect_b32 s47, s70, 0
    s_cselect_b32 s74, s69, 0
    s_cmp_lg_u32 s74, 0
    s_mov_b32 s46, 0x36124925
    s_cselect_b32 s46, 0x36924925, s46
    s_cmp_lg_u32 s47, 0
    s_cselect_b32 s47, 0x3e800000, 0
    v_and_b32 v5, 15, v0
    v_lshrrev_b32 v6, 4, v0
    s_lshl_b32 s69, s3, 4
    v_add_u32 v7, s69, v5
    v_cvt_f32_u32 v8, v7
    v_lshlrev_b32 v9, 2, v6
    v_cvt_f32_u32 v9, v9
    v_mul_f32 v11, 0x3c800000, v8
    v_mul_f32 v12, v11, v9
    v_mul_f32 v13, 0x41500000, v11
    v_cos_f32 v14, v12
    v_sin_f32 v15, v12
    v_add_f32 v12, v12, v11
    v_cvt_pk_bf16_f32 v160, v14, v15
    v_cvt_pk_bf16_f32 v164, -v15, v14
    v_cos_f32 v14, v12
    v_sin_f32 v15, v12
    v_add_f32 v12, v12, v11
    v_cvt_pk_bf16_f32 v161, v14, v15
    v_cvt_pk_bf16_f32 v165, -v15, v14
    v_cos_f32 v14, v12
    v_sin_f32 v15, v12
    v_add_f32 v12, v12, v11
    v_cvt_pk_bf16_f32 v162, v14, v15
    v_cvt_pk_bf16_f32 v166, -v15, v14
    v_cos_f32 v14, v12
    v_sin_f32 v15, v12
    v_add_f32 v12, v12, v13
    v_cvt_pk_bf16_f32 v163, v14, v15
    v_cvt_pk_bf16_f32 v167, -v15, v14
    v_cos_f32 v14, v12
    v_sin_f32 v15, v12
    v_add_f32 v12, v12, v11
    v_cvt_pk_bf16_f32 v168, v14, v15
    v_cvt_pk_bf16_f32 v172, -v15, v14
    v_cos_f32 v14, v12
    v_sin_f32 v15, v12
    v_add_f32 v12, v12, v11
    v_cvt_pk_bf16_f32 v169, v14, v15
    v_cvt_pk_bf16_f32 v173, -v15, v14
    v_cos_f32 v14, v12
    v_sin_f32 v15, v12
    v_add_f32 v12, v12, v11
    v_cvt_pk_bf16_f32 v170, v14, v15
    v_cvt_pk_bf16_f32 v174, -v15, v14
    v_cos_f32 v14, v12
    v_sin_f32 v15, v12
    v_add_f32 v12, v12, v13
    v_cvt_pk_bf16_f32 v171, v14, v15
    v_cvt_pk_bf16_f32 v175, -v15, v14
    v_cos_f32 v14, v12
    v_sin_f32 v15, v12
    v_add_f32 v12, v12, v11
    v_cvt_pk_bf16_f32 v176, v14, v15
    v_cvt_pk_bf16_f32 v180, -v15, v14
    v_cos_f32 v14, v12
    v_sin_f32 v15, v12
    v_add_f32 v12, v12, v11
    v_cvt_pk_bf16_f32 v177, v14, v15
    v_cvt_pk_bf16_f32 v181, -v15, v14
    v_cos_f32 v14, v12
    v_sin_f32 v15, v12
    v_add_f32 v12, v12, v11
    v_cvt_pk_bf16_f32 v178, v14, v15
    v_cvt_pk_bf16_f32 v182, -v15, v14
    v_cos_f32 v14, v12
    v_sin_f32 v15, v12
    v_add_f32 v12, v12, v13
    v_cvt_pk_bf16_f32 v179, v14, v15
    v_cvt_pk_bf16_f32 v183, -v15, v14
    v_cos_f32 v14, v12
    v_sin_f32 v15, v12
    v_add_f32 v12, v12, v11
    v_cvt_pk_bf16_f32 v184, v14, v15
    v_cvt_pk_bf16_f32 v188, -v15, v14
    v_cos_f32 v14, v12
    v_sin_f32 v15, v12
    v_add_f32 v12, v12, v11
    v_cvt_pk_bf16_f32 v185, v14, v15
    v_cvt_pk_bf16_f32 v189, -v15, v14
    v_cos_f32 v14, v12
    v_sin_f32 v15, v12
    v_add_f32 v12, v12, v11
    v_cvt_pk_bf16_f32 v186, v14, v15
    v_cvt_pk_bf16_f32 v190, -v15, v14
    v_cos_f32 v14, v12
    v_sin_f32 v15, v12
    v_add_f32 v12, v12, v13
    v_cvt_pk_bf16_f32 v187, v14, v15
    v_cvt_pk_bf16_f32 v191, -v15, v14
    v_cvt_f32_u32 v1, v5
    v_mul_f32 v11, 0x3d000000, v1
    v_mul_f32 v12, v11, v9
    v_mul_f32 v13, 0x41500000, v11
    v_cos_f32 v14, v12
    v_sin_f32 v15, v12
    v_add_f32 v12, v12, v11
    v_cvt_pk_bf16_f32 v192, v14, v15
    v_cvt_pk_bf16_f32 v196, -v15, v14
    v_cos_f32 v14, v12
    v_sin_f32 v15, v12
    v_add_f32 v12, v12, v11
    v_cvt_pk_bf16_f32 v193, v14, v15
    v_cvt_pk_bf16_f32 v197, -v15, v14
    v_cos_f32 v14, v12
    v_sin_f32 v15, v12
    v_add_f32 v12, v12, v11
    v_cvt_pk_bf16_f32 v194, v14, v15
    v_cvt_pk_bf16_f32 v198, -v15, v14
    v_cos_f32 v14, v12
    v_sin_f32 v15, v12
    v_add_f32 v12, v12, v13
    v_cvt_pk_bf16_f32 v195, v14, v15
    v_cvt_pk_bf16_f32 v199, -v15, v14
    v_cos_f32 v14, v12
    v_sin_f32 v15, v12
    v_add_f32 v12, v12, v11
    v_cvt_pk_bf16_f32 v200, v14, v15
    v_cvt_pk_bf16_f32 v204, -v15, v14
    v_cos_f32 v14, v12
    v_sin_f32 v15, v12
    v_add_f32 v12, v12, v11
    v_cvt_pk_bf16_f32 v201, v14, v15
    v_cvt_pk_bf16_f32 v205, -v15, v14
    v_cos_f32 v14, v12
    v_sin_f32 v15, v12
    v_add_f32 v12, v12, v11
    v_cvt_pk_bf16_f32 v202, v14, v15
    v_cvt_pk_bf16_f32 v206, -v15, v14
    v_cos_f32 v14, v12
    v_sin_f32 v15, v12
    v_add_f32 v12, v12, v13
    v_cvt_pk_bf16_f32 v203, v14, v15
    v_cvt_pk_bf16_f32 v207, -v15, v14
    v_add_f32 v2, 0x41800000, v1
    v_mul_f32 v11, 0x3d000000, v2
    v_mul_f32 v12, v11, v9
    v_mul_f32 v13, 0x41500000, v11
    v_cos_f32 v14, v12
    v_sin_f32 v15, v12
    v_add_f32 v12, v12, v11
    v_cvt_pk_bf16_f32 v208, v14, v15
    v_cvt_pk_bf16_f32 v212, -v15, v14
    v_cos_f32 v14, v12
    v_sin_f32 v15, v12
    v_add_f32 v12, v12, v11
    v_cvt_pk_bf16_f32 v209, v14, v15
    v_cvt_pk_bf16_f32 v213, -v15, v14
    v_cos_f32 v14, v12
    v_sin_f32 v15, v12
    v_add_f32 v12, v12, v11
    v_cvt_pk_bf16_f32 v210, v14, v15
    v_cvt_pk_bf16_f32 v214, -v15, v14
    v_cos_f32 v14, v12
    v_sin_f32 v15, v12
    v_add_f32 v12, v12, v13
    v_cvt_pk_bf16_f32 v211, v14, v15
    v_cvt_pk_bf16_f32 v215, -v15, v14
    v_cos_f32 v14, v12
    v_sin_f32 v15, v12
    v_add_f32 v12, v12, v11
    v_cvt_pk_bf16_f32 v216, v14, v15
    v_cvt_pk_bf16_f32 v220, -v15, v14
    v_cos_f32 v14, v12
    v_sin_f32 v15, v12
    v_add_f32 v12, v12, v11
    v_cvt_pk_bf16_f32 v217, v14, v15
    v_cvt_pk_bf16_f32 v221, -v15, v14
    v_cos_f32 v14, v12
    v_sin_f32 v15, v12
    v_add_f32 v12, v12, v11
    v_cvt_pk_bf16_f32 v218, v14, v15
    v_cvt_pk_bf16_f32 v222, -v15, v14
    v_cos_f32 v14, v12
    v_sin_f32 v15, v12
    v_add_f32 v12, v12, v13
    v_cvt_pk_bf16_f32 v219, v14, v15
    v_cvt_pk_bf16_f32 v223, -v15, v14
    v_mul_f32 v11, 0x3a000000, v8
    v_mul_f32 v12, v11, v9
    v_mul_f32 v13, 0x41500000, v11
    v_cos_f32 v224, v12
    v_sin_f32 v228, v12
    v_add_f32 v12, v12, v11
    v_cos_f32 v225, v12
    v_sin_f32 v229, v12
    v_add_f32 v12, v12, v11
    v_cos_f32 v226, v12
    v_sin_f32 v230, v12
    v_add_f32 v12, v12, v11
    v_cos_f32 v227, v12
    v_sin_f32 v231, v12
    v_add_f32 v12, v12, v13
    v_cos_f32 v232, v12
    v_sin_f32 v236, v12
    v_add_f32 v12, v12, v11
    v_cos_f32 v233, v12
    v_sin_f32 v237, v12
    v_add_f32 v12, v12, v11
    v_cos_f32 v234, v12
    v_sin_f32 v238, v12
    v_add_f32 v12, v12, v11
    v_cos_f32 v235, v12
    v_sin_f32 v239, v12
    v_add_f32 v12, v12, v13
    v_cvt_f32_u32 v3, s69
    v_add_f32 v3, v3, v9
    v_mul_f32 v11, 0x3a000000, v1
    v_fma_f32 v12, v11, v3, s47
    v_cos_f32 v14, v12
    v_sin_f32 v15, v12
    v_add_f32 v12, v12, v11
    v_mul_f32 v240, s46, v14
    v_mul_f32 v244, s46, v15
    v_cos_f32 v14, v12
    v_sin_f32 v15, v12
    v_add_f32 v12, v12, v11
    v_mul_f32 v241, s46, v14
    v_mul_f32 v245, s46, v15
    v_cos_f32 v14, v12
    v_sin_f32 v15, v12
    v_add_f32 v12, v12, v11
    v_mul_f32 v242, s46, v14
    v_mul_f32 v246, s46, v15
    v_cos_f32 v14, v12
    v_sin_f32 v15, v12
    v_add_f32 v12, v12, v11
    v_mul_f32 v243, s46, v14
    v_mul_f32 v247, s46, v15
    v_mul_f32 v11, 0x3a000000, v2
    v_fma_f32 v12, v11, v3, s47
    v_cos_f32 v14, v12
    v_sin_f32 v15, v12
    v_add_f32 v12, v12, v11
    v_mul_f32 v248, s46, v14
    v_mul_f32 v252, s46, v15
    v_cos_f32 v14, v12
    v_sin_f32 v15, v12
    v_add_f32 v12, v12, v11
    v_mul_f32 v249, s46, v14
    v_mul_f32 v253, s46, v15
    v_cos_f32 v14, v12
    v_sin_f32 v15, v12
    v_add_f32 v12, v12, v11
    v_mul_f32 v250, s46, v14
    v_mul_f32 v254, s46, v15
    v_cos_f32 v14, v12
    v_sin_f32 v15, v12
    v_add_f32 v12, v12, v11
    v_mul_f32 v251, s46, v14
    v_mul_f32 v255, s46, v15
    s_lshl_b32 s65, s3, 12
    v_and_b32 v5, 31, v0
    v_lshrrev_b32 v6, 5, v0
    v_bfe_u32 v7, v5, 1, 3
    v_lshlrev_b32 v4, 7, v5
    v_add_u32 v4, s65, v4
    v_add_u32 v3, 0, v6
    v_xor_b32 v3, v3, v7
    v_lshl_add_u32 v8, v3, 4, v4
    v_add_u32 v3, 2, v6
    v_xor_b32 v3, v3, v7
    v_lshl_add_u32 v9, v3, 4, v4
    v_add_u32 v3, 4, v6
    v_xor_b32 v3, v3, v7
    v_lshl_add_u32 v10, v3, 4, v4
    v_add_u32 v3, 6, v6
    v_xor_b32 v3, v3, v7
    v_lshl_add_u32 v11, v3, 4, v4
    v_bfe_u32 v2, v0, 2, 2
    v_lshlrev_b32 v2, 2, v2
    v_lshl_add_u32 v2, v6, 1, v2
    v_mul_u32_u24 v2, 0x70, v2
    v_bfe_u32 v3, v0, 4, 1
    v_lshlrev_b32 v3, 5, v3
    v_and_b32 v4, 3, v0
    v_lshl_add_u32 v3, v4, 3, v3
    v_add_u32 v21, v2, v3
    v_add_u32 v21, 0x4000, v21
    v_and_b32 v5, 31, v0
    v_cmp_gt_u32 s[80:81], 32, v0
    v_cmp_gt_u32 vcc, 28, v5
    s_nop 1
    v_cndmask_b32 v22, 0, -1, vcc
    v_mul_u32_u24 v2, 37, v5
    v_lshrrev_b32 v2, 8, v2
    v_mul_u32_u24 v3, 7, v2
    v_sub_u32 v3, v5, v3
    v_cndmask_b32 v2, v3, v2, vcc
    v_cndmask_b32 v3, 7, v3, vcc
    v_and_b32 v4, 4, v3
    v_add_u32 v3, v3, v4
    v_and_b32 v4, 2, v2
    v_add_u32 v2, v2, v4
    v_lshl_add_u32 v2, v2, 2, v3
    v_and_b32 v3, 32, v0
    v_add_lshl_u32 v13, v2, v3, 4
    v_and_b32 v4, 30, v0
    v_cmp_eq_u32 vcc, 28, v4
    v_mov_b32 v15, 0x3f803f80
    s_nop 0
    v_cndmask_b32 v23, 0, v15, vcc
    v_lshlrev_b32 v14, 4, v0
    s_and_b32 s70, s43, 7
    s_lshl_b32 s70, s70, 8
    s_lshl_b32 s71, s40, 3
    s_add_u32 s70, s70, s71
    s_add_u32 s70, s70, s3
    s_lshl_b32 s70, s70, 11
    s_lshr_b32 s71, s43, 3
    s_lshl_b32 s71, s71, 13
    s_add_u32 s70, s70, s71
    s_add_u32 s71, s70, 262144
    s_cmp_ge_u32 s43, 8
    s_cbranch_scc1 K_v_34
    v_add_u32 v16, 116480, v8
    v_add_u32 v17, 116480, v9
    v_add_u32 v18, 116480, v10
    v_add_u32 v19, 116480, v11
    v_add_u32 v20, 116480, v21
    s_barrier
    ds_read_b128 v[96:99], v16
    ds_read_b64_tr_b16 v[100:101], v20 offset:0
    ds_read_b64_tr_b16 v[102:103], v20 offset:112
    ds_read_b64_tr_b16 v[104:105], v20 offset:56
    ds_read_b64_tr_b16 v[106:107], v20 offset:168
    ds_read_b128 v[108:111], v17
    ds_read_b64_tr_b16 v[112:113], v20 offset:1792
    ds_read_b64_tr_b16 v[114:115], v20 offset:1904
    ds_read_b64_tr_b16 v[116:117], v20 offset:1848
    ds_read_b64_tr_b16 v[118:119], v20 offset:1960
    ds_read_b128 v[120:123], v18
    ds_read_b64_tr_b16 v[124:125], v20 offset:3584
    ds_read_b64_tr_b16 v[126:127], v20 offset:3696
    ds_read_b64_tr_b16 v[128:129], v20 offset:3640
    ds_read_b64_tr_b16 v[130:131], v20 offset:3752
    ds_read_b128 v[132:135], v19
    ds_read_b64_tr_b16 v[136:137], v20 offset:5376
    ds_read_b64_tr_b16 v[138:139], v20 offset:5488
    ds_read_b64_tr_b16 v[140:141], v20 offset:5432
    ds_read_b64_tr_b16 v[142:143], v20 offset:5544
    s_waitcnt lgkmcnt(15)
    v_mfma_f32_32x32x16_bf16 v[64:79], v[100:103], v[96:99], 0
    v_mfma_f32_32x32x16_bf16 v[80:95], v[104:107], v[96:99], 0
    s_waitcnt lgkmcnt(0)
    v_add_u32 v16, 140032, v8
    v_add_u32 v17, 140032, v9
    v_add_u32 v18, 140032, v10
    v_add_u32 v19, 140032, v11
    v_add_u32 v20, 140032, v21
    s_barrier
    ds_read_b128 v[144:147], v16
    ds_read_b64_tr_b16 v[148:149], v20 offset:0
    ds_read_b64_tr_b16 v[150:151], v20 offset:112
    ds_read_b64_tr_b16 v[152:153], v20 offset:56
    ds_read_b64_tr_b16 v[154:155], v20 offset:168
    ds_read_b128 v[96:99], v17
    ds_read_b64_tr_b16 v[100:101], v20 offset:1792
    ds_read_b64_tr_b16 v[102:103], v20 offset:1904
    ds_read_b64_tr_b16 v[104:105], v20 offset:1848
    ds_read_b64_tr_b16 v[106:107], v20 offset:1960
    v_mfma_f32_32x32x16_bf16 v[64:79], v[112:115], v[108:111], v[64:79]
    v_mfma_f32_32x32x16_bf16 v[80:95], v[116:119], v[108:111], v[80:95]
    ds_read_b128 v[108:111], v18
    ds_read_b64_tr_b16 v[112:113], v20 offset:3584
    ds_read_b64_tr_b16 v[114:115], v20 offset:3696
    ds_read_b64_tr_b16 v[116:117], v20 offset:3640
    ds_read_b64_tr_b16 v[118:119], v20 offset:3752
    v_mfma_f32_32x32x16_bf16 v[64:79], v[124:127], v[120:123], v[64:79]
    v_mfma_f32_32x32x16_bf16 v[80:95], v[128:131], v[120:123], v[80:95]
    ds_read_b128 v[120:123], v19
    ds_read_b64_tr_b16 v[124:125], v20 offset:5376
    ds_read_b64_tr_b16 v[126:127], v20 offset:5488
    ds_read_b64_tr_b16 v[128:129], v20 offset:5432
    ds_read_b64_tr_b16 v[130:131], v20 offset:5544
    v_mfma_f32_32x32x16_bf16 v[64:79], v[136:139], v[132:135], v[64:79]
    v_mfma_f32_32x32x16_bf16 v[80:95], v[140:143], v[132:135], v[80:95]
    s_waitcnt lgkmcnt(15)
    v_mfma_f32_32x32x16_bf16 v[64:79], v[148:151], v[144:147], v[64:79]
    v_mfma_f32_32x32x16_bf16 v[80:95], v[152:155], v[144:147], v[80:95]
    s_waitcnt lgkmcnt(0)
    v_add_u32 v16, 69376, v8
    v_add_u32 v17, 69376, v9
    v_add_u32 v18, 69376, v10
    v_add_u32 v19, 69376, v11
    v_add_u32 v20, 69376, v21
    s_barrier
    ds_read_b128 v[132:135], v16
    ds_read_b64_tr_b16 v[136:137], v20 offset:0
    ds_read_b64_tr_b16 v[138:139], v20 offset:112
    ds_read_b64_tr_b16 v[140:141], v20 offset:56
    ds_read_b64_tr_b16 v[142:143], v20 offset:168
    ds_read_b128 v[144:147], v17
    ds_read_b64_tr_b16 v[148:149], v20 offset:1792
    ds_read_b64_tr_b16 v[150:151], v20 offset:1904
    ds_read_b64_tr_b16 v[152:153], v20 offset:1848
    ds_read_b64_tr_b16 v[154:155], v20 offset:1960
    v_mfma_f32_32x32x16_bf16 v[64:79], v[100:103], v[96:99], v[64:79]
    v_mfma_f32_32x32x16_bf16 v[80:95], v[104:107], v[96:99], v[80:95]
    ds_read_b128 v[96:99], v18
    ds_read_b64_tr_b16 v[100:101], v20 offset:3584
    ds_read_b64_tr_b16 v[102:103], v20 offset:3696
    ds_read_b64_tr_b16 v[104:105], v20 offset:3640
    ds_read_b64_tr_b16 v[106:107], v20 offset:3752
    v_mfma_f32_32x32x16_bf16 v[64:79], v[112:115], v[108:111], v[64:79]
    v_mfma_f32_32x32x16_bf16 v[80:95], v[116:119], v[108:111], v[80:95]
    ds_read_b128 v[108:111], v19
    ds_read_b64_tr_b16 v[112:113], v20 offset:5376
    ds_read_b64_tr_b16 v[114:115], v20 offset:5488
    ds_read_b64_tr_b16 v[116:117], v20 offset:5432
    ds_read_b64_tr_b16 v[118:119], v20 offset:5544
    v_mfma_f32_32x32x16_bf16 v[64:79], v[124:127], v[120:123], v[64:79]
    v_mfma_f32_32x32x16_bf16 v[80:95], v[128:131], v[120:123], v[80:95]
    s_waitcnt lgkmcnt(15)
    v_mfma_f32_32x32x16_bf16 v[64:79], v[136:139], v[132:135], v[64:79]
    v_mfma_f32_32x32x16_bf16 v[80:95], v[140:143], v[132:135], v[80:95]
    s_waitcnt lgkmcnt(0)
    v_add_u32 v16, 92928, v8
    v_add_u32 v17, 92928, v9
    v_add_u32 v18, 92928, v10
    v_add_u32 v19, 92928, v11
    v_add_u32 v20, 92928, v21
    s_barrier
    ds_read_b128 v[120:123], v16
    ds_read_b64_tr_b16 v[124:125], v20 offset:0
    ds_read_b64_tr_b16 v[126:127], v20 offset:112
    ds_read_b64_tr_b16 v[128:129], v20 offset:56
    ds_read_b64_tr_b16 v[130:131], v20 offset:168
    ds_read_b128 v[132:135], v17
    ds_read_b64_tr_b16 v[136:137], v20 offset:1792
    ds_read_b64_tr_b16 v[138:139], v20 offset:1904
    ds_read_b64_tr_b16 v[140:141], v20 offset:1848
    ds_read_b64_tr_b16 v[142:143], v20 offset:1960
    v_mfma_f32_32x32x16_bf16 v[64:79], v[148:151], v[144:147], v[64:79]
    v_mfma_f32_32x32x16_bf16 v[80:95], v[152:155], v[144:147], v[80:95]
    ds_read_b128 v[144:147], v18
    ds_read_b64_tr_b16 v[148:149], v20 offset:3584
    ds_read_b64_tr_b16 v[150:151], v20 offset:3696
    ds_read_b64_tr_b16 v[152:153], v20 offset:3640
    ds_read_b64_tr_b16 v[154:155], v20 offset:3752
    v_mfma_f32_32x32x16_bf16 v[64:79], v[100:103], v[96:99], v[64:79]
    v_mfma_f32_32x32x16_bf16 v[80:95], v[104:107], v[96:99], v[80:95]
    ds_read_b128 v[96:99], v19
    ds_read_b64_tr_b16 v[100:101], v20 offset:5376
    ds_read_b64_tr_b16 v[102:103], v20 offset:5488
    ds_read_b64_tr_b16 v[104:105], v20 offset:5432
    ds_read_b64_tr_b16 v[106:107], v20 offset:5544
    v_mfma_f32_32x32x16_bf16 v[64:79], v[112:115], v[108:111], v[64:79]
    v_mfma_f32_32x32x16_bf16 v[80:95], v[116:119], v[108:111], v[80:95]
    s_waitcnt lgkmcnt(15)
    v_mfma_f32_32x32x16_bf16 v[64:79], v[124:127], v[120:123], v[64:79]
    v_mfma_f32_32x32x16_bf16 v[80:95], v[128:131], v[120:123], v[80:95]
    s_waitcnt lgkmcnt(0)
    v_add_u32 v16, 116480, v8
    v_add_u32 v17, 116480, v9
    v_add_u32 v18, 116480, v10
    v_add_u32 v19, 116480, v11
    v_add_u32 v20, 116480, v21
    s_barrier
    ds_read_b128 v[108:111], v16
    ds_read_b64_tr_b16 v[112:113], v20 offset:0
    ds_read_b64_tr_b16 v[114:115], v20 offset:112
    ds_read_b64_tr_b16 v[116:117], v20 offset:56
    ds_read_b64_tr_b16 v[118:119], v20 offset:168
    ds_read_b128 v[120:123], v17
    ds_read_b64_tr_b16 v[124:125], v20 offset:1792
    ds_read_b64_tr_b16 v[126:127], v20 offset:1904
    ds_read_b64_tr_b16 v[128:129], v20 offset:1848
    ds_read_b64_tr_b16 v[130:131], v20 offset:1960
    v_mfma_f32_32x32x16_bf16 v[64:79], v[136:139], v[132:135], v[64:79]
    v_mfma_f32_32x32x16_bf16 v[80:95], v[140:143], v[132:135], v[80:95]
    ds_read_b128 v[132:135], v18
    ds_read_b64_tr_b16 v[136:137], v20 offset:3584
    ds_read_b64_tr_b16 v[138:139], v20 offset:3696
    ds_read_b64_tr_b16 v[140:141], v20 offset:3640
    ds_read_b64_tr_b16 v[142:143], v20 offset:3752
    v_mfma_f32_32x32x16_bf16 v[64:79], v[148:151], v[144:147], v[64:79]
    v_mfma_f32_32x32x16_bf16 v[80:95], v[152:155], v[144:147], v[80:95]
    ds_read_b128 v[144:147], v19
    ds_read_b64_tr_b16 v[148:149], v20 offset:5376
    ds_read_b64_tr_b16 v[150:151], v20 offset:5488
    ds_read_b64_tr_b16 v[152:153], v20 offset:5432
    ds_read_b64_tr_b16 v[154:155], v20 offset:5544
    v_mfma_f32_32x32x16_bf16 v[64:79], v[100:103], v[96:99], v[64:79]
    v_mfma_f32_32x32x16_bf16 v[80:95], v[104:107], v[96:99], v[80:95]
    v_mov_b32 v2, 0
    buffer_load_dword v62, v2, s[36:39], 0 offen sc1
    s_waitcnt lgkmcnt(15)
    v_mfma_f32_32x32x16_bf16 v[64:79], v[112:115], v[108:111], v[64:79]
    v_mfma_f32_32x32x16_bf16 v[80:95], v[116:119], v[108:111], v[80:95]
    s_waitcnt lgkmcnt(10)
    v_mfma_f32_32x32x16_bf16 v[64:79], v[124:127], v[120:123], v[64:79]
    v_mfma_f32_32x32x16_bf16 v[80:95], v[128:131], v[120:123], v[80:95]
    s_waitcnt lgkmcnt(5)
    v_mfma_f32_32x32x16_bf16 v[64:79], v[136:139], v[132:135], v[64:79]
    v_mfma_f32_32x32x16_bf16 v[80:95], v[140:143], v[132:135], v[80:95]
    s_waitcnt lgkmcnt(0)
    v_mfma_f32_32x32x16_bf16 v[64:79], v[148:151], v[144:147], v[64:79]
    v_mfma_f32_32x32x16_bf16 v[80:95], v[152:155], v[144:147], v[80:95]
    v_add_u32 v16, 140032, v8
    v_add_u32 v17, 140032, v9
    v_add_u32 v18, 140032, v10
    v_add_u32 v19, 140032, v11
    v_add_u32 v20, 140032, v21
    s_barrier
    ds_read_b128 v[96:99], v16
    ds_read_b64_tr_b16 v[100:101], v20 offset:0
    ds_read_b64_tr_b16 v[102:103], v20 offset:112
    ds_read_b64_tr_b16 v[104:105], v20 offset:56
    ds_read_b64_tr_b16 v[106:107], v20 offset:168
    ds_read_b128 v[108:111], v17
    ds_read_b64_tr_b16 v[112:113], v20 offset:1792
    ds_read_b64_tr_b16 v[114:115], v20 offset:1904
    ds_read_b64_tr_b16 v[116:117], v20 offset:1848
    ds_read_b64_tr_b16 v[118:119], v20 offset:1960
    ds_read_b128 v[120:123], v18
    ds_read_b64_tr_b16 v[124:125], v20 offset:3584
    ds_read_b64_tr_b16 v[126:127], v20 offset:3696
    ds_read_b64_tr_b16 v[128:129], v20 offset:3640
    ds_read_b64_tr_b16 v[130:131], v20 offset:3752
    ds_read_b128 v[132:135], v19
    ds_read_b64_tr_b16 v[136:137], v20 offset:5376
    ds_read_b64_tr_b16 v[138:139], v20 offset:5488
    ds_read_b64_tr_b16 v[140:141], v20 offset:5432
    ds_read_b64_tr_b16 v[142:143], v20 offset:5544
    s_waitcnt lgkmcnt(15)
    v_mfma_f32_32x32x16_bf16 v[64:79], v[100:103], v[96:99], v[64:79]
    v_mfma_f32_32x32x16_bf16 v[80:95], v[104:107], v[96:99], v[80:95]
    s_waitcnt lgkmcnt(10)
    v_mfma_f32_32x32x16_bf16 v[64:79], v[112:115], v[108:111], v[64:79]
    v_mfma_f32_32x32x16_bf16 v[80:95], v[116:119], v[108:111], v[80:95]
    s_waitcnt lgkmcnt(5)
    v_mfma_f32_32x32x16_bf16 v[64:79], v[124:127], v[120:123], v[64:79]
    v_mfma_f32_32x32x16_bf16 v[80:95], v[128:131], v[120:123], v[80:95]
    s_waitcnt lgkmcnt(0)
    v_mfma_f32_32x32x16_bf16 v[64:79], v[136:139], v[132:135], v[64:79]
    v_mfma_f32_32x32x16_bf16 v[80:95], v[140:143], v[132:135], v[80:95]
    v_add_u32 v16, 69376, v8
    v_add_u32 v17, 69376, v9
    v_add_u32 v18, 69376, v10
    v_add_u32 v19, 69376, v11
    v_add_u32 v20, 69376, v21
    s_setprio 3
    s_barrier
    ds_read_b128 v[144:147], v16
    ds_read_b64_tr_b16 v[148:149], v20 offset:0
    ds_read_b64_tr_b16 v[150:151], v20 offset:112
    ds_read_b64_tr_b16 v[152:153], v20 offset:56
    ds_read_b64_tr_b16 v[154:155], v20 offset:168
    ds_read_b128 v[96:99], v17
    ds_read_b64_tr_b16 v[100:101], v20 offset:1792
    ds_read_b64_tr_b16 v[102:103], v20 offset:1904
    ds_read_b64_tr_b16 v[104:105], v20 offset:1848
    ds_read_b64_tr_b16 v[106:107], v20 offset:1960
    ds_read_b128 v[108:111], v18
    ds_read_b64_tr_b16 v[112:113], v20 offset:3584
    ds_read_b64_tr_b16 v[114:115], v20 offset:3696
    ds_read_b64_tr_b16 v[116:117], v20 offset:3640
    ds_read_b64_tr_b16 v[118:119], v20 offset:3752
    ds_read_b128 v[120:123], v19
    ds_read_b64_tr_b16 v[124:125], v20 offset:5376
    ds_read_b64_tr_b16 v[126:127], v20 offset:5488
    ds_read_b64_tr_b16 v[128:129], v20 offset:5432
    ds_read_b64_tr_b16 v[130:131], v20 offset:5544
    s_waitcnt lgkmcnt(15)
    v_mfma_f32_32x32x16_bf16 v[64:79], v[148:151], v[144:147], v[64:79]
    v_mfma_f32_32x32x16_bf16 v[80:95], v[152:155], v[144:147], v[80:95]
    s_waitcnt lgkmcnt(10)
    v_mfma_f32_32x32x16_bf16 v[64:79], v[100:103], v[96:99], v[64:79]
    v_mfma_f32_32x32x16_bf16 v[80:95], v[104:107], v[96:99], v[80:95]
    s_waitcnt lgkmcnt(5)
    v_mfma_f32_32x32x16_bf16 v[64:79], v[112:115], v[108:111], v[64:79]
    v_mfma_f32_32x32x16_bf16 v[80:95], v[116:119], v[108:111], v[80:95]
    s_waitcnt lgkmcnt(0)
    v_mfma_f32_32x32x16_bf16 v[64:79], v[124:127], v[120:123], v[64:79]
    v_mfma_f32_32x32x16_bf16 v[80:95], v[128:131], v[120:123], v[80:95]
    s_nop 10
    v_cvt_pk_bf16_f32 v96, v64, v65
    v_cvt_pk_bf16_f32 v97, v66, v67
    v_cvt_pk_bf16_f32 v98, v68, v69
    v_cvt_pk_bf16_f32 v99, v70, v71
    buffer_store_dwordx4 v[96:99], v14, s[4:7], s70 offen offset:0 sc1
    v_cvt_pk_bf16_f32 v100, v72, v73
    v_cvt_pk_bf16_f32 v101, v74, v75
    v_cvt_pk_bf16_f32 v102, v76, v77
    v_cvt_pk_bf16_f32 v103, v78, v79
    v_cndmask_b32 v102, v15, v102, s[80:81]
    v_cndmask_b32 v103, v15, v103, s[80:81]
    buffer_store_dwordx4 v[100:103], v14, s[4:7], s70 offen offset:1024 sc1
    v_cvt_pk_bf16_f32 v104, v80, v81
    v_cvt_pk_bf16_f32 v105, v82, v83
    v_cvt_pk_bf16_f32 v106, v84, v85
    v_cvt_pk_bf16_f32 v107, v86, v87
    buffer_store_dwordx4 v[104:107], v14, s[4:7], s71 offen offset:0 sc1
    v_cvt_pk_bf16_f32 v108, v88, v89
    v_cvt_pk_bf16_f32 v109, v90, v91
    v_cvt_pk_bf16_f32 v110, v92, v93
    v_cvt_pk_bf16_f32 v111, v94, v95
    v_cndmask_b32 v110, v15, v110, s[80:81]
    v_cndmask_b32 v111, v15, v111, s[80:81]
    buffer_store_dwordx4 v[108:111], v14, s[4:7], s71 offen offset:1024 sc1
    s_branch K_kv_35
K_v_34:
    v_add_u32 v16, 116480, v8
    v_add_u32 v17, 116480, v9
    v_add_u32 v18, 116480, v10
    v_add_u32 v19, 116480, v11
    v_add_u32 v20, 116480, v21
    s_barrier
    ds_read_b128 v[96:99], v16
    ds_read_b64_tr_b16 v[100:101], v20 offset:0
    ds_read_b64_tr_b16 v[102:103], v20 offset:112
    ds_read_b64_tr_b16 v[104:105], v20 offset:56
    ds_read_b64_tr_b16 v[106:107], v20 offset:168
    ds_read_b128 v[108:111], v17
    ds_read_b64_tr_b16 v[112:113], v20 offset:1792
    ds_read_b64_tr_b16 v[114:115], v20 offset:1904
    ds_read_b64_tr_b16 v[116:117], v20 offset:1848
    ds_read_b64_tr_b16 v[118:119], v20 offset:1960
    ds_read_b128 v[120:123], v18
    ds_read_b64_tr_b16 v[124:125], v20 offset:3584
    ds_read_b64_tr_b16 v[126:127], v20 offset:3696
    ds_read_b64_tr_b16 v[128:129], v20 offset:3640
    ds_read_b64_tr_b16 v[130:131], v20 offset:3752
    ds_read_b128 v[132:135], v19
    ds_read_b64_tr_b16 v[136:137], v20 offset:5376
    ds_read_b64_tr_b16 v[138:139], v20 offset:5488
    ds_read_b64_tr_b16 v[140:141], v20 offset:5432
    ds_read_b64_tr_b16 v[142:143], v20 offset:5544
    s_waitcnt lgkmcnt(15)
    v_mfma_f32_32x32x16_bf16 v[64:79], v[96:99], v[100:103], 0
    v_mfma_f32_32x32x16_bf16 v[80:95], v[96:99], v[104:107], 0
    s_waitcnt lgkmcnt(0)
    v_add_u32 v16, 140032, v8
    v_add_u32 v17, 140032, v9
    v_add_u32 v18, 140032, v10
    v_add_u32 v19, 140032, v11
    v_add_u32 v20, 140032, v21
    s_barrier
    ds_read_b128 v[144:147], v16
    ds_read_b64_tr_b16 v[148:149], v20 offset:0
    ds_read_b64_tr_b16 v[150:151], v20 offset:112
    ds_read_b64_tr_b16 v[152:153], v20 offset:56
    ds_read_b64_tr_b16 v[154:155], v20 offset:168
    ds_read_b128 v[96:99], v17
    ds_read_b64_tr_b16 v[100:101], v20 offset:1792
    ds_read_b64_tr_b16 v[102:103], v20 offset:1904
    ds_read_b64_tr_b16 v[104:105], v20 offset:1848
    ds_read_b64_tr_b16 v[106:107], v20 offset:1960
    v_mfma_f32_32x32x16_bf16 v[64:79], v[108:111], v[112:115], v[64:79]
    v_mfma_f32_32x32x16_bf16 v[80:95], v[108:111], v[116:119], v[80:95]
    ds_read_b128 v[108:111], v18
    ds_read_b64_tr_b16 v[112:113], v20 offset:3584
    ds_read_b64_tr_b16 v[114:115], v20 offset:3696
    ds_read_b64_tr_b16 v[116:117], v20 offset:3640
    ds_read_b64_tr_b16 v[118:119], v20 offset:3752
    v_mfma_f32_32x32x16_bf16 v[64:79], v[120:123], v[124:127], v[64:79]
    v_mfma_f32_32x32x16_bf16 v[80:95], v[120:123], v[128:131], v[80:95]
    ds_read_b128 v[120:123], v19
    ds_read_b64_tr_b16 v[124:125], v20 offset:5376
    ds_read_b64_tr_b16 v[126:127], v20 offset:5488
    ds_read_b64_tr_b16 v[128:129], v20 offset:5432
    ds_read_b64_tr_b16 v[130:131], v20 offset:5544
    v_mfma_f32_32x32x16_bf16 v[64:79], v[132:135], v[136:139], v[64:79]
    v_mfma_f32_32x32x16_bf16 v[80:95], v[132:135], v[140:143], v[80:95]
    s_waitcnt lgkmcnt(15)
    v_mfma_f32_32x32x16_bf16 v[64:79], v[144:147], v[148:151], v[64:79]
    v_mfma_f32_32x32x16_bf16 v[80:95], v[144:147], v[152:155], v[80:95]
    s_waitcnt lgkmcnt(0)
    v_add_u32 v16, 69376, v8
    v_add_u32 v17, 69376, v9
    v_add_u32 v18, 69376, v10
    v_add_u32 v19, 69376, v11
    v_add_u32 v20, 69376, v21
    s_barrier
    ds_read_b128 v[132:135], v16
    ds_read_b64_tr_b16 v[136:137], v20 offset:0
    ds_read_b64_tr_b16 v[138:139], v20 offset:112
    ds_read_b64_tr_b16 v[140:141], v20 offset:56
    ds_read_b64_tr_b16 v[142:143], v20 offset:168
    ds_read_b128 v[144:147], v17
    ds_read_b64_tr_b16 v[148:149], v20 offset:1792
    ds_read_b64_tr_b16 v[150:151], v20 offset:1904
    ds_read_b64_tr_b16 v[152:153], v20 offset:1848
    ds_read_b64_tr_b16 v[154:155], v20 offset:1960
    v_mfma_f32_32x32x16_bf16 v[64:79], v[96:99], v[100:103], v[64:79]
    v_mfma_f32_32x32x16_bf16 v[80:95], v[96:99], v[104:107], v[80:95]
    ds_read_b128 v[96:99], v18
    ds_read_b64_tr_b16 v[100:101], v20 offset:3584
    ds_read_b64_tr_b16 v[102:103], v20 offset:3696
    ds_read_b64_tr_b16 v[104:105], v20 offset:3640
    ds_read_b64_tr_b16 v[106:107], v20 offset:3752
    v_mfma_f32_32x32x16_bf16 v[64:79], v[108:111], v[112:115], v[64:79]
    v_mfma_f32_32x32x16_bf16 v[80:95], v[108:111], v[116:119], v[80:95]
    ds_read_b128 v[108:111], v19
    ds_read_b64_tr_b16 v[112:113], v20 offset:5376
    ds_read_b64_tr_b16 v[114:115], v20 offset:5488
    ds_read_b64_tr_b16 v[116:117], v20 offset:5432
    ds_read_b64_tr_b16 v[118:119], v20 offset:5544
    v_mfma_f32_32x32x16_bf16 v[64:79], v[120:123], v[124:127], v[64:79]
    v_mfma_f32_32x32x16_bf16 v[80:95], v[120:123], v[128:131], v[80:95]
    s_waitcnt lgkmcnt(15)
    v_mfma_f32_32x32x16_bf16 v[64:79], v[132:135], v[136:139], v[64:79]
    v_mfma_f32_32x32x16_bf16 v[80:95], v[132:135], v[140:143], v[80:95]
    s_waitcnt lgkmcnt(0)
    v_add_u32 v16, 92928, v8
    v_add_u32 v17, 92928, v9
    v_add_u32 v18, 92928, v10
    v_add_u32 v19, 92928, v11
    v_add_u32 v20, 92928, v21
    s_barrier
    ds_read_b128 v[120:123], v16
    ds_read_b64_tr_b16 v[124:125], v20 offset:0
    ds_read_b64_tr_b16 v[126:127], v20 offset:112
    ds_read_b64_tr_b16 v[128:129], v20 offset:56
    ds_read_b64_tr_b16 v[130:131], v20 offset:168
    ds_read_b128 v[132:135], v17
    ds_read_b64_tr_b16 v[136:137], v20 offset:1792
    ds_read_b64_tr_b16 v[138:139], v20 offset:1904
    ds_read_b64_tr_b16 v[140:141], v20 offset:1848
    ds_read_b64_tr_b16 v[142:143], v20 offset:1960
    v_mfma_f32_32x32x16_bf16 v[64:79], v[144:147], v[148:151], v[64:79]
    v_mfma_f32_32x32x16_bf16 v[80:95], v[144:147], v[152:155], v[80:95]
    ds_read_b128 v[144:147], v18
    ds_read_b64_tr_b16 v[148:149], v20 offset:3584
    ds_read_b64_tr_b16 v[150:151], v20 offset:3696
    ds_read_b64_tr_b16 v[152:153], v20 offset:3640
    ds_read_b64_tr_b16 v[154:155], v20 offset:3752
    v_mfma_f32_32x32x16_bf16 v[64:79], v[96:99], v[100:103], v[64:79]
    v_mfma_f32_32x32x16_bf16 v[80:95], v[96:99], v[104:107], v[80:95]
    ds_read_b128 v[96:99], v19
    ds_read_b64_tr_b16 v[100:101], v20 offset:5376
    ds_read_b64_tr_b16 v[102:103], v20 offset:5488
    ds_read_b64_tr_b16 v[104:105], v20 offset:5432
    ds_read_b64_tr_b16 v[106:107], v20 offset:5544
    v_mfma_f32_32x32x16_bf16 v[64:79], v[108:111], v[112:115], v[64:79]
    v_mfma_f32_32x32x16_bf16 v[80:95], v[108:111], v[116:119], v[80:95]
    s_waitcnt lgkmcnt(15)
    v_mfma_f32_32x32x16_bf16 v[64:79], v[120:123], v[124:127], v[64:79]
    v_mfma_f32_32x32x16_bf16 v[80:95], v[120:123], v[128:131], v[80:95]
    s_waitcnt lgkmcnt(0)
    v_add_u32 v16, 116480, v8
    v_add_u32 v17, 116480, v9
    v_add_u32 v18, 116480, v10
    v_add_u32 v19, 116480, v11
    v_add_u32 v20, 116480, v21
    s_barrier
    ds_read_b128 v[108:111], v16
    ds_read_b64_tr_b16 v[112:113], v20 offset:0
    ds_read_b64_tr_b16 v[114:115], v20 offset:112
    ds_read_b64_tr_b16 v[116:117], v20 offset:56
    ds_read_b64_tr_b16 v[118:119], v20 offset:168
    ds_read_b128 v[120:123], v17
    ds_read_b64_tr_b16 v[124:125], v20 offset:1792
    ds_read_b64_tr_b16 v[126:127], v20 offset:1904
    ds_read_b64_tr_b16 v[128:129], v20 offset:1848
    ds_read_b64_tr_b16 v[130:131], v20 offset:1960
    v_mfma_f32_32x32x16_bf16 v[64:79], v[132:135], v[136:139], v[64:79]
    v_mfma_f32_32x32x16_bf16 v[80:95], v[132:135], v[140:143], v[80:95]
    ds_read_b128 v[132:135], v18
    ds_read_b64_tr_b16 v[136:137], v20 offset:3584
    ds_read_b64_tr_b16 v[138:139], v20 offset:3696
    ds_read_b64_tr_b16 v[140:141], v20 offset:3640
    ds_read_b64_tr_b16 v[142:143], v20 offset:3752
    v_mfma_f32_32x32x16_bf16 v[64:79], v[144:147], v[148:151], v[64:79]
    v_mfma_f32_32x32x16_bf16 v[80:95], v[144:147], v[152:155], v[80:95]
    ds_read_b128 v[144:147], v19
    ds_read_b64_tr_b16 v[148:149], v20 offset:5376
    ds_read_b64_tr_b16 v[150:151], v20 offset:5488
    ds_read_b64_tr_b16 v[152:153], v20 offset:5432
    ds_read_b64_tr_b16 v[154:155], v20 offset:5544
    v_mfma_f32_32x32x16_bf16 v[64:79], v[96:99], v[100:103], v[64:79]
    v_mfma_f32_32x32x16_bf16 v[80:95], v[96:99], v[104:107], v[80:95]
    v_mov_b32 v2, 0
    buffer_load_dword v62, v2, s[36:39], 0 offen sc1
    s_waitcnt lgkmcnt(15)
    v_mfma_f32_32x32x16_bf16 v[64:79], v[108:111], v[112:115], v[64:79]
    v_mfma_f32_32x32x16_bf16 v[80:95], v[108:111], v[116:119], v[80:95]
    s_waitcnt lgkmcnt(10)
    v_mfma_f32_32x32x16_bf16 v[64:79], v[120:123], v[124:127], v[64:79]
    v_mfma_f32_32x32x16_bf16 v[80:95], v[120:123], v[128:131], v[80:95]
    s_waitcnt lgkmcnt(5)
    v_mfma_f32_32x32x16_bf16 v[64:79], v[132:135], v[136:139], v[64:79]
    v_mfma_f32_32x32x16_bf16 v[80:95], v[132:135], v[140:143], v[80:95]
    s_waitcnt lgkmcnt(0)
    v_mfma_f32_32x32x16_bf16 v[64:79], v[144:147], v[148:151], v[64:79]
    v_mfma_f32_32x32x16_bf16 v[80:95], v[144:147], v[152:155], v[80:95]
    v_add_u32 v16, 140032, v8
    v_add_u32 v17, 140032, v9
    v_add_u32 v18, 140032, v10
    v_add_u32 v19, 140032, v11
    v_add_u32 v20, 140032, v21
    s_barrier
    ds_read_b128 v[96:99], v16
    ds_read_b64_tr_b16 v[100:101], v20 offset:0
    ds_read_b64_tr_b16 v[102:103], v20 offset:112
    ds_read_b64_tr_b16 v[104:105], v20 offset:56
    ds_read_b64_tr_b16 v[106:107], v20 offset:168
    ds_read_b128 v[108:111], v17
    ds_read_b64_tr_b16 v[112:113], v20 offset:1792
    ds_read_b64_tr_b16 v[114:115], v20 offset:1904
    ds_read_b64_tr_b16 v[116:117], v20 offset:1848
    ds_read_b64_tr_b16 v[118:119], v20 offset:1960
    ds_read_b128 v[120:123], v18
    ds_read_b64_tr_b16 v[124:125], v20 offset:3584
    ds_read_b64_tr_b16 v[126:127], v20 offset:3696
    ds_read_b64_tr_b16 v[128:129], v20 offset:3640
    ds_read_b64_tr_b16 v[130:131], v20 offset:3752
    ds_read_b128 v[132:135], v19
    ds_read_b64_tr_b16 v[136:137], v20 offset:5376
    ds_read_b64_tr_b16 v[138:139], v20 offset:5488
    ds_read_b64_tr_b16 v[140:141], v20 offset:5432
    ds_read_b64_tr_b16 v[142:143], v20 offset:5544
    s_waitcnt lgkmcnt(15)
    v_mfma_f32_32x32x16_bf16 v[64:79], v[96:99], v[100:103], v[64:79]
    v_mfma_f32_32x32x16_bf16 v[80:95], v[96:99], v[104:107], v[80:95]
    s_waitcnt lgkmcnt(10)
    v_mfma_f32_32x32x16_bf16 v[64:79], v[108:111], v[112:115], v[64:79]
    v_mfma_f32_32x32x16_bf16 v[80:95], v[108:111], v[116:119], v[80:95]
    s_waitcnt lgkmcnt(5)
    v_mfma_f32_32x32x16_bf16 v[64:79], v[120:123], v[124:127], v[64:79]
    v_mfma_f32_32x32x16_bf16 v[80:95], v[120:123], v[128:131], v[80:95]
    s_waitcnt lgkmcnt(0)
    v_mfma_f32_32x32x16_bf16 v[64:79], v[132:135], v[136:139], v[64:79]
    v_mfma_f32_32x32x16_bf16 v[80:95], v[132:135], v[140:143], v[80:95]
    v_add_u32 v16, 69376, v8
    v_add_u32 v17, 69376, v9
    v_add_u32 v18, 69376, v10
    v_add_u32 v19, 69376, v11
    v_add_u32 v20, 69376, v21
    s_setprio 3
    s_barrier
    ds_read_b128 v[144:147], v16
    ds_read_b64_tr_b16 v[148:149], v20 offset:0
    ds_read_b64_tr_b16 v[150:151], v20 offset:112
    ds_read_b64_tr_b16 v[152:153], v20 offset:56
    ds_read_b64_tr_b16 v[154:155], v20 offset:168
    ds_read_b128 v[96:99], v17
    ds_read_b64_tr_b16 v[100:101], v20 offset:1792
    ds_read_b64_tr_b16 v[102:103], v20 offset:1904
    ds_read_b64_tr_b16 v[104:105], v20 offset:1848
    ds_read_b64_tr_b16 v[106:107], v20 offset:1960
    ds_read_b128 v[108:111], v18
    ds_read_b64_tr_b16 v[112:113], v20 offset:3584
    ds_read_b64_tr_b16 v[114:115], v20 offset:3696
    ds_read_b64_tr_b16 v[116:117], v20 offset:3640
    ds_read_b64_tr_b16 v[118:119], v20 offset:3752
    ds_read_b128 v[120:123], v19
    ds_read_b64_tr_b16 v[124:125], v20 offset:5376
    ds_read_b64_tr_b16 v[126:127], v20 offset:5488
    ds_read_b64_tr_b16 v[128:129], v20 offset:5432
    ds_read_b64_tr_b16 v[130:131], v20 offset:5544
    s_waitcnt lgkmcnt(15)
    v_mfma_f32_32x32x16_bf16 v[64:79], v[144:147], v[148:151], v[64:79]
    v_mfma_f32_32x32x16_bf16 v[80:95], v[144:147], v[152:155], v[80:95]
    s_waitcnt lgkmcnt(10)
    v_mfma_f32_32x32x16_bf16 v[64:79], v[96:99], v[100:103], v[64:79]
    v_mfma_f32_32x32x16_bf16 v[80:95], v[96:99], v[104:107], v[80:95]
    s_waitcnt lgkmcnt(5)
    v_mfma_f32_32x32x16_bf16 v[64:79], v[108:111], v[112:115], v[64:79]
    v_mfma_f32_32x32x16_bf16 v[80:95], v[108:111], v[116:119], v[80:95]
    s_waitcnt lgkmcnt(0)
    v_mfma_f32_32x32x16_bf16 v[64:79], v[120:123], v[124:127], v[64:79]
    v_mfma_f32_32x32x16_bf16 v[80:95], v[120:123], v[128:131], v[80:95]
    s_nop 10
    v_cvt_pk_bf16_f32 v96, v64, v65
    v_cvt_pk_bf16_f32 v97, v66, v67
    v_cvt_pk_bf16_f32 v98, v68, v69
    v_cvt_pk_bf16_f32 v99, v70, v71
    v_and_or_b32 v96, v96, v22, v23
    v_and_or_b32 v97, v97, v22, v23
    v_and_or_b32 v98, v98, v22, v23
    v_and_or_b32 v99, v99, v22, v23
    buffer_store_dwordx4 v[96:99], v13, s[4:7], s70 offen offset:0 sc1
    v_cvt_pk_bf16_f32 v100, v72, v73
    v_cvt_pk_bf16_f32 v101, v74, v75
    v_cvt_pk_bf16_f32 v102, v76, v77
    v_cvt_pk_bf16_f32 v103, v78, v79
    v_and_or_b32 v100, v100, v22, v23
    v_and_or_b32 v101, v101, v22, v23
    v_and_or_b32 v102, v102, v22, v23
    v_and_or_b32 v103, v103, v22, v23
    buffer_store_dwordx4 v[100:103], v13, s[4:7], s70 offen offset:1024 sc1
    v_cvt_pk_bf16_f32 v104, v80, v81
    v_cvt_pk_bf16_f32 v105, v82, v83
    v_cvt_pk_bf16_f32 v106, v84, v85
    v_cvt_pk_bf16_f32 v107, v86, v87
    v_and_or_b32 v104, v104, v22, v23
    v_and_or_b32 v105, v105, v22, v23
    v_and_or_b32 v106, v106, v22, v23
    v_and_or_b32 v107, v107, v22, v23
    buffer_store_dwordx4 v[104:107], v13, s[4:7], s71 offen offset:0 sc1
    v_cvt_pk_bf16_f32 v108, v88, v89
    v_cvt_pk_bf16_f32 v109, v90, v91
    v_cvt_pk_bf16_f32 v110, v92, v93
    v_cvt_pk_bf16_f32 v111, v94, v95
    v_and_or_b32 v108, v108, v22, v23
    v_and_or_b32 v109, v109, v22, v23
    v_and_or_b32 v110, v110, v22, v23
    v_and_or_b32 v111, v111, v22, v23
    buffer_store_dwordx4 v[108:111], v13, s[4:7], s71 offen offset:1024 sc1
K_kv_35:
    s_waitcnt vmcnt(4)
    s_mov_b32 s62, 65536
EP_36:
    v_readfirstlane_b32 s0, v62
    s_sub_u32 s62, s62, 1
    s_cselect_b32 s0, 1, s0
    s_cmp_lg_u32 s0, 0
    s_cbranch_scc1 EP_37
    s_mov_b32 s63, 6
EP_38:
    s_nop 15
    s_sub_u32 s63, s63, 1
    s_cbranch_scc0 EP_38
    v_mov_b32 v2, 0
    buffer_load_dword v62, v2, s[36:39], 0 offen sc1
    s_waitcnt vmcnt(0)
    s_branch EP_36
EP_37:
    s_lshr_b32 s60, 3, s3
    s_bitcmp1_b32 s60, 0
    s_cbranch_scc0 K_sk_39
    v_mul_u32_u24 v2, 57, v0
    v_lshrrev_b32 v2, 9, v2
    v_sub_u32 v2, v0, v2
    v_subrev_u32 v3, 56, v2
    v_min_u32 v2, v2, v3
    v_lshlrev_b32 v2, 4, v2
    v_add_u32 v4, 64, v0
    v_mul_u32_u24 v3, 57, v4
    v_lshrrev_b32 v3, 9, v3
    v_sub_u32 v3, v4, v3
    v_subrev_u32 v4, 56, v3
    v_min_u32 v3, v3, v4
    v_subrev_u32 v4, 56, v3
    v_min_u32 v3, v3, v4
    v_lshlrev_b32 v3, 4, v3
    s_and_b32 s75, s3, 1
    s_lshr_b32 s72, s44, 4
    s_lshl_b32 s72, s72, 7
    s_and_b32 s73, s44, 15
    s_lshl_b32 s73, s73, 1
    s_add_u32 s72, s72, s73
    s_add_u32 s72, s72, s75
    s_mul_i32 s72, s72, 896
    s_mul_i32 s73, s75, 8208
    s_add_u32 s73, s73, 0
    s_waitcnt lgkmcnt(0)
    s_add_u32 s74, s72, 0
    s_add_u32 m0, s73, 0
    s_nop 0
    buffer_load_dwordx4 v2, s[8:11], s74 offen  lds
    s_add_u32 m0, s73, 1024
    s_nop 0
    buffer_load_dwordx4 v3, s[8:11], s74 offen  lds
    s_add_u32 s74, s72, 28672
    s_add_u32 m0, s73, 2052
    s_nop 0
    buffer_load_dwordx4 v2, s[8:11], s74 offen  lds
    s_add_u32 m0, s73, 3076
    s_nop 0
    buffer_load_dwordx4 v3, s[8:11], s74 offen  lds
    s_add_u32 s74, s72, 57344
    s_add_u32 m0, s73, 4104
    s_nop 0
    buffer_load_dwordx4 v2, s[8:11], s74 offen  lds
    s_add_u32 m0, s73, 5128
    s_nop 0
    buffer_load_dwordx4 v3, s[8:11], s74 offen  lds
    s_add_u32 s74, s72, 86016
    s_add_u32 m0, s73, 6156
    s_nop 0
    buffer_load_dwordx4 v2, s[8:11], s74 offen  lds
    s_add_u32 m0, s73, 7180
    s_nop 0
    buffer_load_dwordx4 v3, s[8:11], s74 offen  lds
K_sk_39:
    v_lshrrev_b32 v2, 2, v0
    v_lshlrev_b32 v2, 7, v2
    v_and_b32 v9, 3, v0
    v_lshl_add_u32 v2, v9, 4, v2
    v_mov_b32 v4, s0
    v_mov_b32 v5, s0
    v_mov_b32 v6, s0
    v_mov_b32 v7, s0
    v_mov_b32 v9, 163712
    v_mov_b32 v3, 1
    s_and_b32 s60, s43, 7
    s_lshl_b32 s60, s60, 12
    s_lshr_b32 s61, s43, 3
    s_lshl_b32 s61, s61, 4
    s_add_u32 s60, s60, s61
    s_and_b32 s61, s40, 12
    s_add_u32 s60, s60, s61
    s_and_b32 s61, s40, 3
    s_lshl_b32 s61, s61, 5
    s_add_u32 s60, s60, s61
    s_add_u32 s60, s60, 12582912
    s_add_u32 s61, s60, 2048
    s_mov_b64 exec, 1
    s_waitcnt vmcnt(8)
    s_cmp_lt_u32 s3, 2
    s_cbranch_scc1 K_w_41
    s_waitcnt vmcnt(0)
K_w_41:
    ds_add_rtn_u32 v8, v9, v3
    s_mov_b64 exec, -1
    s_waitcnt lgkmcnt(0)
    v_readfirstlane_b32 s62, v8
    s_nop 0
    s_cmp_lg_u32 s62, 3
    s_cbranch_scc1 LS_sk_40
    s_mov_b32 exec_lo, 0x11111111
    s_mov_b32 exec_hi, 0x11111111
    buffer_atomic_swap v4, v2, s[4:7], s61 offen sc1
    s_mov_b32 exec_lo, 0x11111111
    s_mov_b32 exec_hi, 0x11111111
    buffer_atomic_swap v4, v2, s[4:7], s60 offen sc1
    s_mov_b64 exec, -1
LS_sk_40:
    s_lshr_b32 s60, 3, s3
    s_bitcmp1_b32 s60, 0
    s_cbranch_scc0 K_e_42
    s_setprio 2
    v_and_b32 v136, 31, v0
    v_lshrrev_b32 v137, 5, v0
    v_cvt_f32_u32 v138, v136
    v_mul_f32 v138, 0x3c800000, v138
    v_cvt_f32_u32 v139, v137
    v_mul_f32 v140, v138, v139
    v_add_f32 v138, v138, v138
    v_cmp_eq_u32 s[76:77], 0, v136
    v_mov_b32 v141, 0x3f803f80
    v_lshlrev_b32 v142, 15, v137
    v_lshl_or_b32 v142, v137, 31, v142
    v_or_b32 v141, v141, v142
    v_cos_f32 v143, v140
    v_sin_f32 v144, v140
    v_add_f32 v140, v140, v138
    v_cos_f32 v145, v140
    v_sin_f32 v146, v140
    v_add_f32 v140, v140, v138
    v_cvt_pk_bf16_f32 v24, v143, v145
    v_cvt_pk_bf16_f32 v147, -v144, -v146
    v_cndmask_b32 v40, v147, v141, s[76:77]
    v_cos_f32 v143, v140
    v_sin_f32 v144, v140
    v_add_f32 v140, v140, v138
    v_cos_f32 v145, v140
    v_sin_f32 v146, v140
    v_add_f32 v140, v140, v138
    v_cvt_pk_bf16_f32 v25, v143, v145
    v_cvt_pk_bf16_f32 v147, -v144, -v146
    v_cndmask_b32 v41, v147, v141, s[76:77]
    v_cos_f32 v143, v140
    v_sin_f32 v144, v140
    v_add_f32 v140, v140, v138
    v_cos_f32 v145, v140
    v_sin_f32 v146, v140
    v_add_f32 v140, v140, v138
    v_cvt_pk_bf16_f32 v26, v143, v145
    v_cvt_pk_bf16_f32 v147, -v144, -v146
    v_cndmask_b32 v42, v147, v141, s[76:77]
    v_cos_f32 v143, v140
    v_sin_f32 v144, v140
    v_add_f32 v140, v140, v138
    v_cos_f32 v145, v140
    v_sin_f32 v146, v140
    v_add_f32 v140, v140, v138
    v_cvt_pk_bf16_f32 v27, v143, v145
    v_cvt_pk_bf16_f32 v147, -v144, -v146
    v_cndmask_b32 v43, v147, v141, s[76:77]
    v_cos_f32 v143, v140
    v_sin_f32 v144, v140
    v_add_f32 v140, v140, v138
    v_cos_f32 v145, v140
    v_sin_f32 v146, v140
    v_add_f32 v140, v140, v138
    v_cvt_pk_bf16_f32 v28, v143, v145
    v_cvt_pk_bf16_f32 v147, -v144, -v146
    v_cndmask_b32 v44, v147, v141, s[76:77]
    v_cos_f32 v143, v140
    v_sin_f32 v144, v140
    v_add_f32 v140, v140, v138
    v_cos_f32 v145, v140
    v_sin_f32 v146, v140
    v_add_f32 v140, v140, v138
    v_cvt_pk_bf16_f32 v29, v143, v145
    v_cvt_pk_bf16_f32 v147, -v144, -v146
    v_cndmask_b32 v45, v147, v141, s[76:77]
    v_cos_f32 v143, v140
    v_sin_f32 v144, v140
    v_add_f32 v140, v140, v138
    v_cos_f32 v145, v140
    v_sin_f32 v146, v140
    v_add_f32 v140, v140, v138
    v_cvt_pk_bf16_f32 v30, v143, v145
    v_cvt_pk_bf16_f32 v147, -v144, -v146
    v_cndmask_b32 v46, v147, v141, s[76:77]
    v_cos_f32 v143, v140
    v_sin_f32 v144, v140
    v_add_f32 v140, v140, v138
    v_cos_f32 v145, v140
    v_sin_f32 v146, v140
    v_add_f32 v140, v140, v138
    v_cvt_pk_bf16_f32 v31, v143, v145
    v_cvt_pk_bf16_f32 v147, -v144, -v146
    v_cndmask_b32 v47, v147, v141, s[76:77]
    v_cos_f32 v143, v140
    v_sin_f32 v144, v140
    v_add_f32 v140, v140, v138
    v_cos_f32 v145, v140
    v_sin_f32 v146, v140
    v_add_f32 v140, v140, v138
    v_cvt_pk_bf16_f32 v32, v143, v145
    v_cvt_pk_bf16_f32 v147, -v144, -v146
    v_cndmask_b32 v48, v147, v141, s[76:77]
    v_cos_f32 v143, v140
    v_sin_f32 v144, v140
    v_add_f32 v140, v140, v138
    v_cos_f32 v145, v140
    v_sin_f32 v146, v140
    v_add_f32 v140, v140, v138
    v_cvt_pk_bf16_f32 v33, v143, v145
    v_cvt_pk_bf16_f32 v147, -v144, -v146
    v_cndmask_b32 v49, v147, v141, s[76:77]
    v_cos_f32 v143, v140
    v_sin_f32 v144, v140
    v_add_f32 v140, v140, v138
    v_cos_f32 v145, v140
    v_sin_f32 v146, v140
    v_add_f32 v140, v140, v138
    v_cvt_pk_bf16_f32 v34, v143, v145
    v_cvt_pk_bf16_f32 v147, -v144, -v146
    v_cndmask_b32 v50, v147, v141, s[76:77]
    v_cos_f32 v143, v140
    v_sin_f32 v144, v140
    v_add_f32 v140, v140, v138
    v_cos_f32 v145, v140
    v_sin_f32 v146, v140
    v_add_f32 v140, v140, v138
    v_cvt_pk_bf16_f32 v35, v143, v145
    v_cvt_pk_bf16_f32 v147, -v144, -v146
    v_cndmask_b32 v51, v147, v141, s[76:77]
    v_cos_f32 v143, v140
    v_sin_f32 v144, v140
    v_add_f32 v140, v140, v138
    v_cos_f32 v145, v140
    v_sin_f32 v146, v140
    v_add_f32 v140, v140, v138
    v_cvt_pk_bf16_f32 v36, v143, v145
    v_cvt_pk_bf16_f32 v147, -v144, -v146
    v_cndmask_b32 v52, v147, v141, s[76:77]
    v_cos_f32 v143, v140
    v_sin_f32 v144, v140
    v_add_f32 v140, v140, v138
    v_cos_f32 v145, v140
    v_sin_f32 v146, v140
    v_add_f32 v140, v140, v138
    v_cvt_pk_bf16_f32 v37, v143, v145
    v_cvt_pk_bf16_f32 v147, -v144, -v146
    v_cndmask_b32 v53, v147, v141, s[76:77]
    v_cos_f32 v143, v140
    v_sin_f32 v144, v140
    v_add_f32 v140, v140, v138
    v_cos_f32 v145, v140
    v_sin_f32 v146, v140
    v_add_f32 v140, v140, v138
    v_cvt_pk_bf16_f32 v38, v143, v145
    v_cvt_pk_bf16_f32 v147, -v144, -v146
    v_cndmask_b32 v54, v147, v141, s[76:77]
    v_cos_f32 v143, v140
    v_sin_f32 v144, v140
    v_add_f32 v140, v140, v138
    v_cos_f32 v145, v140
    v_sin_f32 v146, v140
    v_add_f32 v140, v140, v138
    v_cvt_pk_bf16_f32 v39, v143, v145
    v_cvt_pk_bf16_f32 v147, -v144, -v146
    v_cndmask_b32 v55, v147, v141, s[76:77]
    v_bfe_u32 v143, v136, 2, 1
    v_bfe_u32 v144, v136, 3, 1
    v_bfe_u32 v145, v136, 1, 1
    v_lshl_add_u32 v145, v144, 1, v145
    v_lshl_add_u32 v146, v143, 2, v145
    v_cmp_gt_u32 s[78:79], 16, v136
    s_nop 1
    v_cndmask_b32 v147, v145, v146, s[78:79]
    v_cvt_f32_u32 v147, v147
    v_mul_f32 v147, 0x3e124925, v147
    v_and_b32 v148, 1, v136
    v_cvt_f32_u32 v148, v148
    v_mul_f32 v148, 0x3e800000, v148
    v_mul_f32 v149, 4.0, v139
    v_fma_f32 v148, v149, v147, v148
    v_cmp_gt_u32 vcc, 7, v146
    s_nop 0
    s_and_b64 s[80:81], vcc, s[78:79]
    v_cmp_eq_u32 vcc, 0, v143
    s_nop 0
    s_andn2_b64 s[82:83], vcc, s[78:79]
    s_or_b64 s[82:83], s[82:83], s[80:81]
    v_cmp_eq_u32 vcc, 1, v143
    s_nop 0
    s_andn2_b64 s[58:59], vcc, s[78:79]
    v_cos_f32 v143, v148
    v_sin_f32 v144, v148
    v_add_f32 v148, v148, v147
    v_cndmask_b32 v145, 0, v143, s[82:83]
    v_cndmask_b32 v146, 0, v144, s[80:81]
    v_cndmask_b32 v146, v146, v143, s[58:59]
    v_cvt_pk_bf16_f32 v56, v145, v146
    v_cos_f32 v143, v148
    v_sin_f32 v144, v148
    v_add_f32 v148, v148, v147
    v_cndmask_b32 v145, 0, v143, s[82:83]
    v_cndmask_b32 v146, 0, v144, s[80:81]
    v_cndmask_b32 v146, v146, v143, s[58:59]
    v_cvt_pk_bf16_f32 v57, v145, v146
    v_cos_f32 v143, v148
    v_sin_f32 v144, v148
    v_add_f32 v148, v148, v147
    v_cndmask_b32 v145, 0, v143, s[82:83]
    v_cndmask_b32 v146, 0, v144, s[80:81]
    v_cndmask_b32 v146, v146, v143, s[58:59]
    v_cvt_pk_bf16_f32 v58, v145, v146
    v_cos_f32 v143, v148
    v_sin_f32 v144, v148
    v_add_f32 v148, v148, v147
    v_cndmask_b32 v145, 0, v143, s[82:83]
    v_cndmask_b32 v146, 0, v144, s[80:81]
    v_cndmask_b32 v146, v146, v143, s[58:59]
    v_cvt_pk_bf16_f32 v59, v145, v146
    v_cmp_gt_u32 vcc, 32, v0
    s_nop 1
    v_cndmask_b32 v59, 0, v59, vcc
    s_and_b32 s75, s3, 1
    s_mul_i32 s73, s75, 8208
    s_add_u32 s73, s73, 0
    v_lshrrev_b32 v143, 3, v136
    v_mul_u32_u24 v143, 0x804, v143
    v_and_b32 v144, 7, v136
    v_mul_u32_u24 v144, 0x90, v144
    v_mul_u32_u24 v145, 14, v137
    v_add3_u32 v143, v143, v144, v145
    v_add_u32 v60, s73, v143
    v_lshl_add_u32 v144, v137, 7, v136
    v_lshlrev_b32 v144, 6, v136
    v_lshlrev_b32 v145, 13, v137
    s_lshl_b32 s74, s75, 4
    v_add3_u32 v61, s74, v144, v145
    s_setprio 3
    s_waitcnt vmcnt(0)
    ds_read_u16 v64, v60 offset:0
    ds_read_u16 v65, v60 offset:28
    ds_read_u16 v66, v60 offset:56
    ds_read_u16 v67, v60 offset:84
    ds_read_u16 v68, v60 offset:112
    ds_read_u16 v69, v60 offset:156
    ds_read_u16 v70, v60 offset:184
    ds_read_u16 v71, v60 offset:212
    ds_read_u16 v72, v60 offset:240
    ds_read_u16 v73, v60 offset:268
    ds_read_u16 v74, v60 offset:312
    ds_read_u16 v75, v60 offset:340
    ds_read_u16 v76, v60 offset:368
    ds_read_u16 v77, v60 offset:396
    ds_read_u16 v78, v60 offset:440
    ds_read_u16 v79, v60 offset:468
    ds_read_u16 v80, v60 offset:496
    ds_read_u16 v81, v60 offset:524
    ds_read_u16 v82, v60 offset:552
    ds_read_u16 v83, v60 offset:596
    ds_read_u16 v84, v60 offset:624
    ds_read_u16 v85, v60 offset:652
    ds_read_u16 v86, v60 offset:680
    ds_read_u16 v87, v60 offset:724
    ds_read_u16 v88, v60 offset:752
    ds_read_u16 v89, v60 offset:780
    ds_read_u16 v90, v60 offset:808
    ds_read_u16 v91, v60 offset:836
    ds_read_u16 v92, v60 offset:880
    ds_read_u16 v93, v60 offset:908
    ds_read_u16 v94, v60 offset:936
    ds_read_u16 v95, v60 offset:964
    s_waitcnt lgkmcnt(15)
    v_lshl_or_b32 v96, v65, 16, v64
    v_lshl_or_b32 v97, v67, 16, v66
    v_lshl_or_b32 v98, v69, 16, v68
    v_lshl_or_b32 v99, v71, 16, v70
    s_nop 1
    v_mfma_f32_32x32x16_bf16 v[112:127], v[96:99], v[24:27], 0
    v_mfma_f32_32x32x16_bf16 v[128:143], v[96:99], v[40:43], 0
    s_waitcnt lgkmcnt(15)
    v_lshl_or_b32 v100, v73, 16, v72
    v_lshl_or_b32 v101, v75, 16, v74
    v_lshl_or_b32 v102, v77, 16, v76
    v_lshl_or_b32 v103, v79, 16, v78
    s_nop 1
    v_mfma_f32_32x32x16_bf16 v[112:127], v[100:103], v[28:31], v[112:127]
    v_mfma_f32_32x32x16_bf16 v[128:143], v[100:103], v[44:47], v[128:143]
    s_waitcnt lgkmcnt(8)
    v_lshl_or_b32 v104, v81, 16, v80
    v_lshl_or_b32 v105, v83, 16, v82
    v_lshl_or_b32 v106, v85, 16, v84
    v_lshl_or_b32 v107, v87, 16, v86
    s_nop 1
    v_mfma_f32_32x32x16_bf16 v[112:127], v[104:107], v[32:35], v[112:127]
    v_mfma_f32_32x32x16_bf16 v[128:143], v[104:107], v[48:51], v[128:143]
    s_waitcnt lgkmcnt(0)
    v_lshl_or_b32 v108, v89, 16, v88
    v_lshl_or_b32 v109, v91, 16, v90
    v_lshl_or_b32 v110, v93, 16, v92
    v_lshl_or_b32 v111, v95, 16, v94
    s_nop 1
    v_mfma_f32_32x32x16_bf16 v[112:127], v[108:111], v[36:39], v[112:127]
    v_mfma_f32_32x32x16_bf16 v[128:143], v[108:111], v[52:55], v[128:143]
    v_mov_b32 v2, 163764
    v_mov_b32 v3, 1
    s_mov_b64 exec, 1
    ds_add_u32 v2, v3
    s_mov_b64 exec, -1
    s_nop 6
    v_cvt_pk_bf16_f32 v144, v112, v128
    v_cvt_pk_bf16_f32 v145, v113, v129
    v_cvt_pk_bf16_f32 v146, v114, v130
    v_cvt_pk_bf16_f32 v147, v115, v131
    v_cvt_pk_bf16_f32 v148, v116, v132
    v_cvt_pk_bf16_f32 v149, v117, v133
    v_cvt_pk_bf16_f32 v150, v118, v134
    v_cvt_pk_bf16_f32 v151, v119, v135
    v_cvt_pk_bf16_f32 v152, v120, v136
    v_cvt_pk_bf16_f32 v153, v121, v137
    v_cvt_pk_bf16_f32 v154, v122, v138
    v_cvt_pk_bf16_f32 v155, v123, v139
    v_cvt_pk_bf16_f32 v156, v124, v140
    v_cvt_pk_bf16_f32 v157, v125, v141
    v_cvt_pk_bf16_f32 v158, v126, v142
    v_cvt_pk_bf16_f32 v159, v127, v143
    v_mfma_f32_32x32x16_bf16 v[64:79], v[56:59], v[144:147], 0
    v_mfma_f32_32x32x16_bf16 v[80:95], v[56:59], v[148:151], 0
    v_mfma_f32_32x32x16_bf16 v[96:111], v[56:59], v[152:155], 0
    v_mfma_f32_32x32x16_bf16 v[112:127], v[56:59], v[156:159], 0
    s_nop 8
    v_cvt_pk_bf16_f32 v128, v64, v65
    v_cvt_pk_bf16_f32 v132, v66, v67
    v_cvt_pk_bf16_f32 v136, v68, v69
    v_cvt_pk_bf16_f32 v140, v70, v71
    v_cvt_pk_bf16_f32 v129, v80, v81
    v_cvt_pk_bf16_f32 v133, v82, v83
    v_cvt_pk_bf16_f32 v137, v84, v85
    v_cvt_pk_bf16_f32 v141, v86, v87
    v_cvt_pk_bf16_f32 v130, v96, v97
    v_cvt_pk_bf16_f32 v134, v98, v99
    v_cvt_pk_bf16_f32 v138, v100, v101
    v_cvt_pk_bf16_f32 v142, v102, v103
    v_cvt_pk_bf16_f32 v131, v112, v113
    v_cvt_pk_bf16_f32 v135, v114, v115
    v_cvt_pk_bf16_f32 v139, v116, v117
    v_cvt_pk_bf16_f32 v143, v118, v119
    s_mov_b64 exec, s[76:77]
    v_cvt_pk_bf16_f32 v128, v72, v73
    v_cvt_pk_bf16_f32 v132, v74, v75
    v_cvt_pk_bf16_f32 v136, v76, v77
    v_cvt_pk_bf16_f32 v140, v78, v79
    v_cvt_pk_bf16_f32 v129, v88, v89
    v_cvt_pk_bf16_f32 v133, v90, v91
    v_cvt_pk_bf16_f32 v137, v92, v93
    v_cvt_pk_bf16_f32 v141, v94, v95
    v_cvt_pk_bf16_f32 v130, v104, v105
    v_cvt_pk_bf16_f32 v134, v106, v107
    v_cvt_pk_bf16_f32 v138, v108, v109
    v_cvt_pk_bf16_f32 v142, v110, v111
    v_cvt_pk_bf16_f32 v131, v120, v121
    v_cvt_pk_bf16_f32 v135, v122, v123
    v_cvt_pk_bf16_f32 v139, v124, v125
    v_cvt_pk_bf16_f32 v143, v126, v127
    s_mov_b64 exec, -1
    v_mov_b32 v2, 163764
    s_mov_b32 s62, 1048576
CS_44:
    ds_read_b32 v3, v2
    s_waitcnt lgkmcnt(0)
    v_cmp_gt_u32 vcc, 2, v3
    s_sub_u32 s62, s62, 1
    s_cselect_b64 vcc, 0, vcc
    s_cbranch_vccnz CS_44
    ds_write_b128 v61, v[128:131] offset:0
    ds_write_b128 v61, v[132:135] offset:2048
    ds_write_b128 v61, v[136:139] offset:4096
    ds_write_b128 v61, v[140:143] offset:6144
    s_and_b32 s75, s3, 1
    s_lshl_b32 s75, s75, 11
    v_lshlrev_b32 v2, 4, v0
    v_add_u32 v2, s75, v2
    ds_read_b128 v[24:27], v2 offset:33024
    ds_read_b128 v[28:31], v2 offset:34048
    s_branch K_e_43
K_e_42:
    s_setprio 2
    v_lshrrev_b32 v3, 5, v0
    v_cvt_f32_u32 v8, v3
    v_mul_f32 v8, 4.0, v8
    v_and_b32 v4, 7, v0
    v_bfe_u32 v6, v0, 3, 2
    v_cmp_gt_u32 s[58:59], 7, v4
    v_cmp_eq_u32 vcc, 0, v6
    s_nop 0
    s_and_b64 s[76:77], vcc, s[58:59]
    v_cmp_eq_u32 vcc, 1, v6
    s_nop 0
    s_and_b64 s[78:79], vcc, s[58:59]
    v_cmp_eq_u32 vcc, 2, v6
    s_nop 0
    s_and_b64 s[80:81], vcc, s[58:59]
    v_cmp_eq_u32 vcc, 3, v6
    s_nop 0
    s_and_b64 s[82:83], vcc, s[58:59]
    v_cvt_f32_u32 v7, v4
    v_mul_f32 v7, 0x3e124925, v7
    v_mul_f32 v9, v7, v8
    v_cos_f32 v10, v9
    v_sin_f32 v11, v9
    v_add_f32 v9, v9, v7
    v_cvt_pk_bf16_f32 v4, v10, -v11
    v_cvt_pk_bf16_f32 v6, v11, v10
    v_cndmask_b32 v32, 0, v4, s[76:77]
    v_cndmask_b32 v36, 0, v6, s[76:77]
    v_cndmask_b32 v33, 0, v4, s[78:79]
    v_cndmask_b32 v37, 0, v6, s[78:79]
    v_cndmask_b32 v34, 0, v4, s[80:81]
    v_cndmask_b32 v38, 0, v6, s[80:81]
    v_cndmask_b32 v35, 0, v4, s[82:83]
    v_cndmask_b32 v39, 0, v6, s[82:83]
    v_cos_f32 v10, v9
    v_sin_f32 v11, v9
    v_add_f32 v9, v9, v7
    v_cvt_pk_bf16_f32 v4, v10, -v11
    v_cvt_pk_bf16_f32 v6, v11, v10
    v_cndmask_b32 v40, 0, v4, s[76:77]
    v_cndmask_b32 v44, 0, v6, s[76:77]
    v_cndmask_b32 v41, 0, v4, s[78:79]
    v_cndmask_b32 v45, 0, v6, s[78:79]
    v_cndmask_b32 v42, 0, v4, s[80:81]
    v_cndmask_b32 v46, 0, v6, s[80:81]
    v_cndmask_b32 v43, 0, v4, s[82:83]
    v_cndmask_b32 v47, 0, v6, s[82:83]
    v_cos_f32 v10, v9
    v_sin_f32 v11, v9
    v_add_f32 v9, v9, v7
    v_cvt_pk_bf16_f32 v4, v10, -v11
    v_cvt_pk_bf16_f32 v6, v11, v10
    v_cndmask_b32 v48, 0, v4, s[76:77]
    v_cndmask_b32 v52, 0, v6, s[76:77]
    v_cndmask_b32 v49, 0, v4, s[78:79]
    v_cndmask_b32 v53, 0, v6, s[78:79]
    v_cndmask_b32 v50, 0, v4, s[80:81]
    v_cndmask_b32 v54, 0, v6, s[80:81]
    v_cndmask_b32 v51, 0, v4, s[82:83]
    v_cndmask_b32 v55, 0, v6, s[82:83]
    s_mov_b32 s77, 0
    s_mov_b32 s79, 0
    s_mov_b32 s81, 0
    s_mov_b32 s83, 0
    v_cos_f32 v10, v9
    v_sin_f32 v11, v9
    v_add_f32 v9, v9, v7
    v_cvt_pk_bf16_f32 v4, v10, -v11
    v_cvt_pk_bf16_f32 v6, v11, v10
    v_cndmask_b32 v56, 0, v4, s[76:77]
    v_cndmask_b32 v60, 0, v6, s[76:77]
    v_cndmask_b32 v57, 0, v4, s[78:79]
    v_cndmask_b32 v61, 0, v6, s[78:79]
    v_cndmask_b32 v58, 0, v4, s[80:81]
    v_cndmask_b32 v62, 0, v6, s[80:81]
    v_cndmask_b32 v59, 0, v4, s[82:83]
    v_cndmask_b32 v63, 0, v6, s[82:83]
    v_lshrrev_b32 v3, 5, v0
    v_cvt_f32_u32 v8, v3
    v_mul_f32 v8, 4.0, v8
    v_and_b32 v2, 31, v0
    v_cvt_f32_u32 v6, v2
    v_mul_f32 v6, 0x3c800000, v6
    v_mul_f32 v9, v6, v8
    v_mul_f32 v7, 0x40a00000, v6
    v_cos_f32 v10, v9
    v_sin_f32 v11, v9
    v_add_f32 v9, v9, v6
    v_cvt_pk_bf16_f32 v96, v10, -v11
    v_cos_f32 v10, v9
    v_sin_f32 v11, v9
    v_add_f32 v9, v9, v6
    v_cvt_pk_bf16_f32 v97, v10, -v11
    v_cos_f32 v10, v9
    v_sin_f32 v11, v9
    v_add_f32 v9, v9, v6
    v_cvt_pk_bf16_f32 v98, v10, -v11
    v_cos_f32 v10, v9
    v_sin_f32 v11, v9
    v_add_f32 v9, v9, v7
    v_cvt_pk_bf16_f32 v99, v10, -v11
    v_cos_f32 v10, v9
    v_sin_f32 v11, v9
    v_add_f32 v9, v9, v6
    v_cvt_pk_bf16_f32 v100, v10, -v11
    v_cos_f32 v10, v9
    v_sin_f32 v11, v9
    v_add_f32 v9, v9, v6
    v_cvt_pk_bf16_f32 v101, v10, -v11
    v_cos_f32 v10, v9
    v_sin_f32 v11, v9
    v_add_f32 v9, v9, v6
    v_cvt_pk_bf16_f32 v102, v10, -v11
    v_cos_f32 v10, v9
    v_sin_f32 v11, v9
    v_add_f32 v9, v9, v7
    v_cvt_pk_bf16_f32 v103, v10, -v11
    v_and_b32 v4, 1, v0
    v_lshlrev_b32 v4, 31, v4
    v_or_b32 v4, 0x3f003f00, v4
    v_cmp_gt_u32 vcc, 32, v0
    s_nop 1
    v_cndmask_b32 v96, v96, v4, vcc
    v_lshrrev_b32 v3, 5, v0
    v_cvt_f32_u32 v8, v3
    v_mul_f32 v8, 4.0, v8
    v_and_b32 v2, 31, v0
    v_cvt_f32_u32 v6, v2
    v_mul_f32 v6, 0x3c800000, v6
    v_add_f32 v8, 0x41800000, v8
    v_mul_f32 v9, v6, v8
    v_mul_f32 v7, 0x40a00000, v6
    v_cos_f32 v10, v9
    v_sin_f32 v11, v9
    v_add_f32 v9, v9, v6
    v_cvt_pk_bf16_f32 v104, v10, -v11
    v_cos_f32 v10, v9
    v_sin_f32 v11, v9
    v_add_f32 v9, v9, v6
    v_cvt_pk_bf16_f32 v105, v10, -v11
    v_cos_f32 v10, v9
    v_sin_f32 v11, v9
    v_add_f32 v9, v9, v6
    v_cvt_pk_bf16_f32 v106, v10, -v11
    v_cos_f32 v10, v9
    v_sin_f32 v11, v9
    v_add_f32 v9, v9, v7
    v_cvt_pk_bf16_f32 v107, v10, -v11
    v_cos_f32 v10, v9
    v_sin_f32 v11, v9
    v_add_f32 v9, v9, v6
    v_cvt_pk_bf16_f32 v108, v10, -v11
    v_cos_f32 v10, v9
    v_sin_f32 v11, v9
    v_add_f32 v9, v9, v6
    v_cvt_pk_bf16_f32 v109, v10, -v11
    v_cos_f32 v10, v9
    v_sin_f32 v11, v9
    v_add_f32 v9, v9, v6
    v_cvt_pk_bf16_f32 v110, v10, -v11
    v_cos_f32 v10, v9
    v_sin_f32 v11, v9
    v_add_f32 v9, v9, v7
    v_cvt_pk_bf16_f32 v111, v10, -v11
    v_lshrrev_b32 v3, 5, v0
    v_cvt_f32_u32 v8, v3
    v_mul_f32 v8, 4.0, v8
    v_and_b32 v2, 31, v0
    v_add_u32 v2, 32, v2
    v_cvt_f32_u32 v6, v2
    v_mul_f32 v6, 0x3c800000, v6
    v_mul_f32 v9, v6, v8
    v_mul_f32 v7, 0x40a00000, v6
    v_cos_f32 v10, v9
    v_sin_f32 v11, v9
    v_add_f32 v9, v9, v6
    v_cvt_pk_bf16_f32 v144, v10, -v11
    v_cos_f32 v10, v9
    v_sin_f32 v11, v9
    v_add_f32 v9, v9, v6
    v_cvt_pk_bf16_f32 v145, v10, -v11
    v_cos_f32 v10, v9
    v_sin_f32 v11, v9
    v_add_f32 v9, v9, v6
    v_cvt_pk_bf16_f32 v146, v10, -v11
    v_cos_f32 v10, v9
    v_sin_f32 v11, v9
    v_add_f32 v9, v9, v7
    v_cvt_pk_bf16_f32 v147, v10, -v11
    v_cos_f32 v10, v9
    v_sin_f32 v11, v9
    v_add_f32 v9, v9, v6
    v_cvt_pk_bf16_f32 v148, v10, -v11
    v_cos_f32 v10, v9
    v_sin_f32 v11, v9
    v_add_f32 v9, v9, v6
    v_cvt_pk_bf16_f32 v149, v10, -v11
    v_cos_f32 v10, v9
    v_sin_f32 v11, v9
    v_add_f32 v9, v9, v6
    v_cvt_pk_bf16_f32 v150, v10, -v11
    v_cos_f32 v10, v9
    v_sin_f32 v11, v9
    v_add_f32 v9, v9, v7
    v_cvt_pk_bf16_f32 v151, v10, -v11
    v_and_b32 v4, 1, v0
    v_lshlrev_b32 v4, 31, v4
    v_or_b32 v4, 0x3f003f00, v4
    v_cmp_gt_u32 vcc, 32, v0
    s_nop 1
    v_cndmask_b32 v144, v144, v4, vcc
    v_lshrrev_b32 v3, 5, v0
    v_cvt_f32_u32 v8, v3
    v_mul_f32 v8, 4.0, v8
    v_and_b32 v2, 31, v0
    v_add_u32 v2, 32, v2
    v_cvt_f32_u32 v6, v2
    v_mul_f32 v6, 0x3c800000, v6
    v_add_f32 v8, 0x41800000, v8
    v_mul_f32 v9, v6, v8
    v_mul_f32 v7, 0x40a00000, v6
    v_cos_f32 v10, v9
    v_sin_f32 v11, v9
    v_add_f32 v9, v9, v6
    v_cvt_pk_bf16_f32 v152, v10, -v11
    v_cos_f32 v10, v9
    v_sin_f32 v11, v9
    v_add_f32 v9, v9, v6
    v_cvt_pk_bf16_f32 v153, v10, -v11
    v_cos_f32 v10, v9
    v_sin_f32 v11, v9
    v_add_f32 v9, v9, v6
    v_cvt_pk_bf16_f32 v154, v10, -v11
    v_cos_f32 v10, v9
    v_sin_f32 v11, v9
    v_add_f32 v9, v9, v7
    v_cvt_pk_bf16_f32 v155, v10, -v11
    v_cos_f32 v10, v9
    v_sin_f32 v11, v9
    v_add_f32 v9, v9, v6
    v_cvt_pk_bf16_f32 v156, v10, -v11
    v_cos_f32 v10, v9
    v_sin_f32 v11, v9
    v_add_f32 v9, v9, v6
    v_cvt_pk_bf16_f32 v157, v10, -v11
    v_cos_f32 v10, v9
    v_sin_f32 v11, v9
    v_add_f32 v9, v9, v6
    v_cvt_pk_bf16_f32 v158, v10, -v11
    v_cos_f32 v10, v9
    v_sin_f32 v11, v9
    v_add_f32 v9, v9, v7
    v_cvt_pk_bf16_f32 v159, v10, -v11
    s_setprio 3
    v_mov_b32 v2, 163764
    s_mov_b32 s62, 1048576
    s_branch CS_47
CS_46:
    s_nop 15
    s_nop 15
    s_nop 15
    s_nop 15
    s_nop 15
CS_47:
    ds_read_b32 v3, v2
    s_waitcnt lgkmcnt(0)
    v_cmp_gt_u32 vcc, 2, v3
    s_sub_u32 s62, s62, 1
    s_cselect_b64 vcc, 0, vcc
    s_cbranch_vccnz CS_46
K_e_43:
    s_lshr_b32 s72, s44, 5
    s_lshl_b32 s72, s72, 8
    s_and_b32 s73, s44, 31
    s_lshl_b32 s73, s73, 1
    s_add_u32 s72, s72, s73
    s_and_b32 s75, s3, 1
    s_add_u32 s72, s72, s75
    s_and_b32 s79, s3, 2
    s_lshl_b32 s73, s79, 6
    s_add_u32 s72, s72, s73
    s_lshl_b32 s79, s79, 10
    v_and_b32 v2, 31, v0
    v_mov_b32 v3, 0x40000000
    v_cmp_gt_u32 vcc, 29, v2
    v_lshlrev_b32 v2, 4, v2
    s_nop 0
    v_cndmask_b32 v2, v3, v2, vcc
    v_cmp_gt_u32 vcc, 32, v0
    s_lshl_b32 s73, s75, 13
    s_add_u32 s73, s73, s79
    s_add_u32 s73, s73, 16416
    s_add_u32 s74, s72, 0
    s_sub_u32 s78, 0, s74
    s_and_b32 s78, s78, 0x7ff
    s_mul_i32 s74, s74, 450
    s_and_b32 s74, s74, 0xfffffffc
    s_mul_i32 s78, s78, 450
    s_and_b32 s78, s78, 0xfffffffc
    v_mov_b32 v3, s78
    v_mov_b32 v4, s74
    v_cndmask_b32 v3, v3, v4, vcc
    v_add_u32 v64, v3, v2
    s_add_u32 s74, s72, 64
    s_sub_u32 s78, 0, s74
    s_and_b32 s78, s78, 0x7ff
    s_mul_i32 s74, s74, 450
    s_and_b32 s74, s74, 0xfffffffc
    s_mul_i32 s78, s78, 450
    s_and_b32 s78, s78, 0xfffffffc
    v_mov_b32 v3, s78
    v_mov_b32 v4, s74
    v_cndmask_b32 v3, v3, v4, vcc
    v_add_u32 v65, v3, v2
    s_lshl_b32 s75, s75, 4
    s_lshr_b32 s74, s79, 8
    s_add_u32 s75, s75, s74
    v_lshlrev_b32 v11, 6, v0
    v_add_u32 v11, s75, v11
    s_waitcnt lgkmcnt(0)
    v_add_u32 v24, s79, v24
    v_add_u32 v25, s79, v25
    v_add_u32 v26, s79, v26
    v_add_u32 v27, s79, v27
    v_and_b32 v2, 3, v0
    v_lshlrev_b32 v2, 2, v2
    v_add_u32 v2, 163776, v2
    s_mov_b32 s62, 1048576
    s_branch CS_49
CS_48:
    s_nop 15
    s_nop 15
    s_nop 15
    s_nop 15
    s_nop 15
CS_49:
    ds_read_b32 v3, v2
    s_waitcnt lgkmcnt(0)
    v_cmp_gt_u32 vcc, 1, v3
    s_sub_u32 s62, s62, 1
    s_cselect_b64 vcc, 0, vcc
    s_cbranch_vccnz CS_48
    s_add_u32 m0, s73, 0
    s_nop 0
    buffer_load_dwordx4 v64, s[12:15], 0 offen  lds
    s_nop 15
    s_nop 15
    s_nop 15
    s_add_u32 m0, s73, 4096
    s_nop 0
    buffer_load_dwordx4 v64, s[16:19], 0 offen  lds
    s_nop 15
    s_nop 15
    s_nop 15
    s_add_u32 m0, s73, 1024
    s_nop 0
    buffer_load_dwordx4 v65, s[12:15], 0 offen  lds
    s_nop 15
    s_nop 15
    s_nop 15
    s_add_u32 m0, s73, 5120
    s_nop 0
    buffer_load_dwordx4 v65, s[16:19], 0 offen  lds
    s_lshl_b32 s75, s3, 12
    v_add_u32 v10, s75, v14
    s_lshl_b32 s74, s44, 14
    s_add_u32 s74, s74, 6291456
    s_waitcnt vmcnt(0)
    ds_read_u16 v64, v24 offset:0
    ds_read_u16 v65, v24 offset:4096
    ds_read_u16 v66, v24 offset:1024
    ds_read_u16 v67, v24 offset:5120
    ds_read_u16 v68, v25 offset:0
    ds_read_u16 v69, v25 offset:4096
    ds_read_u16 v70, v25 offset:1024
    ds_read_u16 v71, v25 offset:5120
    ds_read_u16 v72, v26 offset:0
    ds_read_u16 v73, v26 offset:4096
    ds_read_u16 v74, v26 offset:1024
    ds_read_u16 v75, v26 offset:5120
    ds_read_u16 v76, v27 offset:0
    ds_read_u16 v77, v27 offset:4096
    ds_read_u16 v78, v27 offset:1024
    ds_read_u16 v79, v27 offset:5120
    s_waitcnt lgkmcnt(12)
    v_lshl_or_b32 v128, v65, 16, v64
    v_xor_b32 v128, v128, v28
    v_lshl_or_b32 v129, v67, 16, v66
    v_xor_b32 v129, v129, v28
    ds_write_b64 v11, v[128:129] offset:32
    s_waitcnt lgkmcnt(9)
    v_lshl_or_b32 v130, v69, 16, v68
    v_xor_b32 v130, v130, v29
    v_lshl_or_b32 v131, v71, 16, v70
    v_xor_b32 v131, v131, v29
    ds_write_b64 v11, v[130:131] offset:4128
    s_waitcnt lgkmcnt(6)
    v_lshl_or_b32 v132, v73, 16, v72
    v_xor_b32 v132, v132, v30
    v_lshl_or_b32 v133, v75, 16, v74
    v_xor_b32 v133, v133, v30
    ds_write_b64 v11, v[132:133] offset:8224
    s_waitcnt lgkmcnt(3)
    v_lshl_or_b32 v134, v77, 16, v76
    v_xor_b32 v134, v134, v31
    v_lshl_or_b32 v135, v79, 16, v78
    v_xor_b32 v135, v135, v31
    ds_write_b64 v11, v[134:135] offset:12320
    v_mov_b32 v2, 163768
    v_mov_b32 v3, 1
    s_mov_b64 exec, 1
    ds_add_u32 v2, v3
    s_mov_b64 exec, -1
    s_mov_b32 s62, 1048576
SR_50:
    ds_read_b32 v3, v2
    ds_read_b128 v[128:131], v10 offset:0
    ds_read_b128 v[132:135], v10 offset:1024
    ds_read_b128 v[136:139], v10 offset:2048
    ds_read_b128 v[140:143], v10 offset:3072
    s_sub_u32 s62, s62, 1
    s_waitcnt lgkmcnt(4)
    v_cmp_gt_u32 vcc, 4, v3
    s_nop 0
    s_cselect_b64 vcc, 0, vcc
    s_cbranch_vccnz SR_50
    s_waitcnt lgkmcnt(3)
    buffer_store_dwordx4 v[128:131], v10, s[4:7], s74 offen offset:0 sc1
    s_nop 15
    s_nop 15
    s_waitcnt lgkmcnt(2)
    buffer_store_dwordx4 v[132:135], v10, s[4:7], s74 offen offset:1024 sc1
    s_nop 15
    s_nop 15
    s_waitcnt lgkmcnt(1)
    buffer_store_dwordx4 v[136:139], v10, s[4:7], s74 offen offset:2048 sc1
    s_nop 15
    s_nop 15
    s_waitcnt lgkmcnt(0)
    buffer_store_dwordx4 v[140:143], v10, s[4:7], s74 offen offset:3072 sc1
    v_lshrrev_b32 v2, 2, v0
    v_lshlrev_b32 v2, 10, v2
    v_and_b32 v9, 3, v0
    v_lshl_add_u32 v2, v9, 4, v2
    v_mov_b32 v4, s0
    v_mov_b32 v5, s0
    v_mov_b32 v6, s0
    v_mov_b32 v7, s0
    v_mov_b32 v9, 163716
    v_mov_b32 v3, 1
    s_lshr_b32 s60, s2, 4
    s_lshl_b32 s60, s60, 14
    s_and_b32 s61, s2, 15
    s_lshl_b32 s61, s61, 2
    s_add_u32 s60, s60, s61
    s_add_u32 s60, s60, 15728640
    s_lshl_b32 s61, s2, 2
    s_add_u32 s61, s61, 15990784
    s_mov_b64 exec, 1
    s_waitcnt vmcnt(0)
    ds_add_rtn_u32 v8, v9, v3
    s_mov_b64 exec, -1
    s_waitcnt lgkmcnt(0)
    v_readfirstlane_b32 s62, v8
    s_nop 0
    s_cmp_lg_u32 s62, 3
    s_cbranch_scc1 LS_sk_51
    s_mov_b64 exec, 1
    buffer_atomic_swap v4, v2, s[4:7], s61 offen sc1
    s_mov_b32 exec_lo, 0x11111111
    s_mov_b32 exec_hi, 0x11111111
    buffer_atomic_swap v4, v2, s[4:7], s60 offen sc1
    s_mov_b64 exec, -1
LS_sk_51:
    v_lshrrev_b32 v4, 2, v0
    v_and_b32 v5, 3, v0
    v_lshlrev_b32 v5, 4, v5
    v_lshl_add_u32 v11, v4, 14, v5
    v_bfe_u32 v5, v0, 1, 3
    v_and_b32 v8, 1, v0
    v_lshlrev_b32 v8, 4, v8
    v_lshl_add_u32 v5, v5, 6, v8
    v_lshrrev_b32 v6, 4, v0
    v_lshl_add_u32 v12, v6, 10, v5
    v_lshl_add_u32 v10, v6, 11, v5
    s_lshl_b32 s60, s3, 9
    v_add_u32 v10, s60, v10
    s_lshl_b32 s66, s3, 20
    s_lshl_b32 s61, s44, 6
    s_add_u32 s66, s66, s61
    s_lshl_b32 s67, s3, 12
    s_lshl_b32 s60, s2, 2
    s_add_u32 s60, s60, s3
    s_cmp_ge_u32 s60, 784
    s_cbranch_scc1 K_wf_52
    s_and_b32 s60, s60, 3
    s_cmp_lg_u32 s60, 3
    s_cbranch_scc1 K_wf_52
    s_mul_i32 s50, s2, 0x124a
    s_lshr_b32 s50, s50, 16
    s_mul_i32 s51, s50, 14
    s_sub_u32 s51, s2, s51
    s_mul_i32 s53, s50, 64
    s_mul_i32 s52, s51, 12544
    s_add_u32 s52, s52, s53
    s_add_u32 s52, s52, 225792
    v_and_b32 v2, 3, v0
    v_bfe_u32 v3, v0, 3, 2
    v_lshl_add_u32 v2, v3, 2, v2
    v_bfe_u32 v3, v0, 2, 1
    v_lshl_add_u32 v2, v3, 4, v2
    v_lshrrev_b32 v3, 5, v0
    v_mul_u32_u24 v3, 3136, v3
    v_add_lshl_u32 v2, v2, v3, 1
    v_add_u32 v3, 0xe00, v2
    buffer_load_ushort v16, v2, s[28:31], s52 offen offset:0
    buffer_load_ushort v17, v2, s[28:31], s52 offen offset:896
    buffer_load_ushort v18, v2, s[28:31], s52 offen offset:1792
    buffer_load_ushort v19, v2, s[28:31], s52 offen offset:2688
    buffer_load_ushort v20, v3, s[28:31], s52 offen offset:0
    buffer_load_ushort v21, v3, s[28:31], s52 offen offset:896
    buffer_load_ushort v22, v3, s[28:31], s52 offen offset:1792
    s_lshl_b32 s50, s50, 14
    s_lshl_b32 s53, s51, 10
    s_add_u32 s50, s50, s53
    s_add_u32 s50, s50, 16777216
    s_waitcnt vmcnt(0)
    v_lshl_or_b32 v16, v17, 16, v16
    v_lshl_or_b32 v17, v19, 16, v18
    v_lshl_or_b32 v18, v21, 16, v20
    s_lshl_b32 s51, s0, 16
    s_bitset1_b32 s51, 31
    v_or_b32 v19, s51, v22
    buffer_store_dwordx4 v[16:19], v14, s[4:7], s50 offen sc1
K_wf_52:
    s_lshr_b32 s60, 1, s3
    s_bitcmp1_b32 s60, 0
    s_cbranch_scc0 K_e_53
    s_lshl_b32 s61, s2, 10
    s_add_u32 s61, s61, 15728640
    v_lshlrev_b32 v2, 2, v0
    s_mov_b64 exec, 0xffff
    s_mov_b32 s62, 65536
P_55:
    v_mov_b32 v3, 0
    buffer_atomic_or v3, v2, s[4:7], s61 offen sc0 sc1
    s_waitcnt vmcnt(0)
    v_cmp_ne_u32 vcc, s0, v3
    s_sub_u32 s62, s62, 1
    s_cselect_b64 vcc, 0, vcc
    s_cbranch_vccz P_56
    s_setprio 0
    s_mov_b32 s63, 0
PS_57:
    s_nop 15
    s_nop 15
    s_sub_u32 s63, s63, 1
    s_cbranch_scc0 PS_57
    s_setprio 3
    s_branch P_55
P_56:
    s_mov_b64 exec, -1
    s_mov_b32 s62, 65536
WA_58:
    v_lshlrev_b32 v2, 4, v0
    s_mov_b32 s60, 15990784
    buffer_load_dwordx4 v[4:7], v2, s[4:7], s60 offen sc1
    s_waitcnt vmcnt(0)
WA_61:
    v_xor_b32 v4, s0, v4
    v_xor_b32 v5, s0, v5
    v_xor_b32 v6, s0, v6
    v_xor_b32 v7, s0, v7
    v_or3_b32 v4, v4, v5, v6
    v_or_b32 v4, v4, v7
    v_cmp_ne_u32 vcc, 0, v4
    s_cbranch_vccz WA_59
    s_setprio 0
    s_mov_b64 exec, vcc
    s_bcnt1_i32_b64 s63, vcc
    s_lshr_b32 s63, s63, 1
    s_add_u32 s63, s63, 6
    s_sub_u32 s62, s62, 1
    s_cbranch_scc1 WA_59
WA_60:
    s_nop 15
    s_sub_u32 s63, s63, 1
    s_cbranch_scc0 WA_60
    s_setprio 3
    s_branch WA_58
WA_59:
    s_mov_b64 exec, -1
    s_setprio 3
    v_mov_b32 v2, 163752
    v_mov_b32 v3, 17825792
    s_mov_b64 exec, 1
    ds_add_u32 v2, v3
    s_mov_b64 exec, -1
    s_branch K_e_54
K_e_53:
    v_mov_b32 v2, 163752
    s_mov_b32 s62, 1048576
    s_branch CS_63
CS_62:
    s_nop 15
    s_nop 15
    s_nop 15
    s_nop 15
    s_nop 15
CS_63:
    ds_read_b32 v3, v2
    s_waitcnt lgkmcnt(0)
    v_cmp_gt_u32 vcc, 1, v3
    s_sub_u32 s62, s62, 1
    s_cselect_b64 vcc, 0, vcc
    s_cbranch_vccnz CS_62
K_e_54:
    s_add_u32 m0, s67, 36864
    s_add_u32 s63, s66, 6291456
    buffer_load_dwordx4 v11, s[4:7], s63 offen sc1 lds
    s_nop 15
    s_nop 15
    s_add_u32 m0, s67, 37888
    s_add_u32 s63, s66, 6553600
    buffer_load_dwordx4 v11, s[4:7], s63 offen sc1 lds
    s_nop 15
    s_nop 15
    s_add_u32 m0, s67, 38912
    s_add_u32 s63, s66, 6815744
    buffer_load_dwordx4 v11, s[4:7], s63 offen sc1 lds
    s_nop 15
    s_nop 15
    s_add_u32 m0, s67, 39936
    s_add_u32 s63, s66, 7077888
    buffer_load_dwordx4 v11, s[4:7], s63 offen sc1 lds
    s_waitcnt vmcnt(0)
    v_mov_b32 v2, 163728
    v_mov_b32 v3, 1
    s_mov_b64 exec, 1
    ds_add_u32 v2, v3
    s_mov_b64 exec, -1
    s_mov_b32 s62, 1048576
SR_64:
    ds_read_b32 v3, v2
    ds_read_b128 v[64:67], v12 offset:36864
    ds_read_b128 v[68:71], v12 offset:40960
    ds_read_b128 v[72:75], v12 offset:45056
    ds_read_b128 v[76:79], v12 offset:49152
    ds_read_b128 v[80:83], v12 offset:37376
    ds_read_b128 v[84:87], v12 offset:41472
    ds_read_b128 v[88:91], v12 offset:45568
    ds_read_b128 v[92:95], v12 offset:49664
    ds_read_b128 v[136:139], v10 offset:36896
    ds_read_b128 v[140:143], v10 offset:45088
    s_sub_u32 s62, s62, 1
    s_waitcnt lgkmcnt(10)
    v_cmp_gt_u32 vcc, 4, v3
    s_nop 0
    s_cselect_b64 vcc, 0, vcc
    s_cbranch_vccnz SR_64
    s_waitcnt lgkmcnt(6)
    v_mfma_f32_16x16x32_bf16 v[112:115], v[64:67], v[160:163], 0
    s_nop 4
    v_mfma_f32_16x16x32_bf16 v[116:119], v[64:67], v[164:167], 0
    s_nop 4
    v_mfma_f32_16x16x32_bf16 v[112:115], v[68:71], v[168:171], v[112:115]
    s_nop 4
    v_mfma_f32_16x16x32_bf16 v[116:119], v[68:71], v[172:175], v[116:119]
    s_nop 4
    v_mfma_f32_16x16x32_bf16 v[112:115], v[72:75], v[176:179], v[112:115]
    s_nop 4
    v_mfma_f32_16x16x32_bf16 v[116:119], v[72:75], v[180:183], v[116:119]
    s_nop 4
    v_mfma_f32_16x16x32_bf16 v[112:115], v[76:79], v[184:187], v[112:115]
    s_nop 4
    v_mfma_f32_16x16x32_bf16 v[116:119], v[76:79], v[188:191], v[116:119]
    s_nop 4
    s_waitcnt lgkmcnt(2)
    v_mfma_f32_16x16x32_bf16 v[120:123], v[80:83], v[160:163], 0
    s_nop 4
    v_mfma_f32_16x16x32_bf16 v[124:127], v[80:83], v[164:167], 0
    s_nop 4
    v_mfma_f32_16x16x32_bf16 v[120:123], v[84:87], v[168:171], v[120:123]
    s_nop 4
    v_mfma_f32_16x16x32_bf16 v[124:127], v[84:87], v[172:175], v[124:127]
    s_nop 4
    v_mfma_f32_16x16x32_bf16 v[120:123], v[88:91], v[176:179], v[120:123]
    s_nop 4
    v_mfma_f32_16x16x32_bf16 v[124:127], v[88:91], v[180:183], v[124:127]
    s_nop 4
    v_mfma_f32_16x16x32_bf16 v[120:123], v[92:95], v[184:187], v[120:123]
    s_nop 4
    v_mfma_f32_16x16x32_bf16 v[124:127], v[92:95], v[188:191], v[124:127]
    s_nop 4
    v_pk_mul_f32 v[2:3], v[112:113], v[224:225]
    v_pk_mul_f32 v[4:5], v[116:117], v[224:225]
    v_pk_fma_f32 v[2:3], v[116:117], v[228:229], v[2:3]
    v_pk_fma_f32 v[4:5], v[112:113], v[228:229], v[4:5] neg_lo:[1,0,0] neg_hi:[1,0,0]
    v_cvt_pk_bf16_f32 v128, v2, v4
    v_cvt_pk_bf16_f32 v129, v3, v5
    v_pk_mul_f32 v[6:7], v[114:115], v[226:227]
    v_pk_mul_f32 v[8:9], v[118:119], v[226:227]
    v_pk_fma_f32 v[6:7], v[118:119], v[230:231], v[6:7]
    v_pk_fma_f32 v[8:9], v[114:115], v[230:231], v[8:9] neg_lo:[1,0,0] neg_hi:[1,0,0]
    v_cvt_pk_bf16_f32 v130, v6, v8
    v_cvt_pk_bf16_f32 v131, v7, v9
    v_pk_mul_f32 v[2:3], v[120:121], v[232:233]
    v_pk_mul_f32 v[4:5], v[124:125], v[232:233]
    v_pk_fma_f32 v[2:3], v[124:125], v[236:237], v[2:3]
    v_pk_fma_f32 v[4:5], v[120:121], v[236:237], v[4:5] neg_lo:[1,0,0] neg_hi:[1,0,0]
    v_cvt_pk_bf16_f32 v132, v2, v4
    v_cvt_pk_bf16_f32 v133, v3, v5
    v_pk_mul_f32 v[6:7], v[122:123], v[234:235]
    v_pk_mul_f32 v[8:9], v[126:127], v[234:235]
    v_pk_fma_f32 v[6:7], v[126:127], v[238:239], v[6:7]
    v_pk_fma_f32 v[8:9], v[122:123], v[238:239], v[8:9] neg_lo:[1,0,0] neg_hi:[1,0,0]
    v_cvt_pk_bf16_f32 v134, v6, v8
    v_cvt_pk_bf16_f32 v135, v7, v9
    v_mfma_f32_16x16x32_bf16 v[112:115], v[192:195], v[128:131], 0
    s_nop 4
    v_mfma_f32_16x16x32_bf16 v[116:119], v[196:199], v[128:131], 0
    s_nop 4
    v_mfma_f32_16x16x32_bf16 v[112:115], v[200:203], v[132:135], v[112:115]
    s_nop 4
    v_mfma_f32_16x16x32_bf16 v[116:119], v[204:207], v[132:135], v[116:119]
    s_nop 4
    v_mfma_f32_16x16x32_bf16 v[120:123], v[208:211], v[128:131], 0
    s_nop 4
    v_mfma_f32_16x16x32_bf16 v[124:127], v[212:215], v[128:131], 0
    s_nop 4
    v_mfma_f32_16x16x32_bf16 v[120:123], v[216:219], v[132:135], v[120:123]
    s_nop 4
    v_mfma_f32_16x16x32_bf16 v[124:127], v[220:223], v[132:135], v[124:127]
    s_nop 4
    s_waitcnt lgkmcnt(0)
    v_lshlrev_b32 v72, 16, v136
    v_and_b32 v80, 0xffff0000, v136
    v_lshlrev_b32 v73, 16, v137
    v_and_b32 v81, 0xffff0000, v137
    v_lshlrev_b32 v74, 16, v138
    v_and_b32 v82, 0xffff0000, v138
    v_lshlrev_b32 v75, 16, v139
    v_and_b32 v83, 0xffff0000, v139
    v_lshlrev_b32 v76, 16, v140
    v_and_b32 v84, 0xffff0000, v140
    v_lshlrev_b32 v77, 16, v141
    v_and_b32 v85, 0xffff0000, v141
    v_lshlrev_b32 v78, 16, v142
    v_and_b32 v86, 0xffff0000, v142
    v_lshlrev_b32 v79, 16, v143
    v_and_b32 v87, 0xffff0000, v143
    v_pk_mul_f32 v[2:3], v[116:117], v[72:73]
    v_pk_mul_f32 v[4:5], v[112:113], v[72:73]
    v_pk_fma_f32 v[2:3], v[112:113], v[80:81], v[2:3]
    v_pk_fma_f32 v[4:5], v[116:117], v[80:81], v[4:5] neg_lo:[1,0,0] neg_hi:[1,0,0]
    v_cvt_pk_bf16_f32 v64, v2, v4
    v_cvt_pk_bf16_f32 v65, v3, v5
    v_pk_mul_f32 v[6:7], v[118:119], v[74:75]
    v_pk_mul_f32 v[8:9], v[114:115], v[74:75]
    v_pk_fma_f32 v[6:7], v[114:115], v[82:83], v[6:7]
    v_pk_fma_f32 v[8:9], v[118:119], v[82:83], v[8:9] neg_lo:[1,0,0] neg_hi:[1,0,0]
    v_cvt_pk_bf16_f32 v66, v6, v8
    v_cvt_pk_bf16_f32 v67, v7, v9
    v_pk_mul_f32 v[2:3], v[124:125], v[76:77]
    v_pk_mul_f32 v[4:5], v[120:121], v[76:77]
    v_pk_fma_f32 v[2:3], v[120:121], v[84:85], v[2:3]
    v_pk_fma_f32 v[4:5], v[124:125], v[84:85], v[4:5] neg_lo:[1,0,0] neg_hi:[1,0,0]
    v_cvt_pk_bf16_f32 v68, v2, v4
    v_cvt_pk_bf16_f32 v69, v3, v5
    v_pk_mul_f32 v[6:7], v[126:127], v[78:79]
    v_pk_mul_f32 v[8:9], v[122:123], v[78:79]
    v_pk_fma_f32 v[6:7], v[122:123], v[86:87], v[6:7]
    v_pk_fma_f32 v[8:9], v[126:127], v[86:87], v[8:9] neg_lo:[1,0,0] neg_hi:[1,0,0]
    v_cvt_pk_bf16_f32 v70, v6, v8
    v_cvt_pk_bf16_f32 v71, v7, v9
    v_mfma_f32_16x16x32_bf16 v[112:115], v[64:67], v[192:195], 0
    s_nop 4
    v_mfma_f32_16x16x32_bf16 v[116:119], v[64:67], v[196:199], 0
    s_nop 4
    v_mfma_f32_16x16x32_bf16 v[112:115], v[68:71], v[200:203], v[112:115]
    s_nop 4
    v_mfma_f32_16x16x32_bf16 v[116:119], v[68:71], v[204:207], v[116:119]
    s_nop 4
    v_mfma_f32_16x16x32_bf16 v[120:123], v[64:67], v[208:211], 0
    s_nop 4
    v_mfma_f32_16x16x32_bf16 v[124:127], v[64:67], v[212:215], 0
    s_nop 4
    v_mfma_f32_16x16x32_bf16 v[120:123], v[68:71], v[216:219], v[120:123]
    s_nop 4
    v_mfma_f32_16x16x32_bf16 v[124:127], v[68:71], v[220:223], v[124:127]
    s_nop 4
    s_lshl_b32 s60, s3, 10
    v_add_u32 v11, s60, v14
    v_pk_mul_f32 v[2:3], v[112:113], v[240:241]
    v_pk_mul_f32 v[4:5], v[116:117], v[240:241]
    v_pk_fma_f32 v[2:3], v[116:117], v[244:245], v[2:3]
    v_pk_fma_f32 v[4:5], v[112:113], v[244:245], v[4:5] neg_lo:[1,0,0] neg_hi:[1,0,0]
    v_cvt_pk_bf16_f32 v128, v2, v4
    v_cvt_pk_bf16_f32 v129, v3, v5
    v_pk_mul_f32 v[6:7], v[114:115], v[242:243]
    v_pk_mul_f32 v[8:9], v[118:119], v[242:243]
    v_pk_fma_f32 v[6:7], v[118:119], v[246:247], v[6:7]
    v_pk_fma_f32 v[8:9], v[114:115], v[246:247], v[8:9] neg_lo:[1,0,0] neg_hi:[1,0,0]
    v_cvt_pk_bf16_f32 v130, v6, v8
    v_cvt_pk_bf16_f32 v131, v7, v9
    ds_write_b128 v11, v[128:131] offset:53248
    v_pk_mul_f32 v[2:3], v[120:121], v[248:249]
    v_pk_mul_f32 v[4:5], v[124:125], v[248:249]
    v_pk_fma_f32 v[2:3], v[124:125], v[252:253], v[2:3]
    v_pk_fma_f32 v[4:5], v[120:121], v[252:253], v[4:5] neg_lo:[1,0,0] neg_hi:[1,0,0]
    v_cvt_pk_bf16_f32 v132, v2, v4
    v_cvt_pk_bf16_f32 v133, v3, v5
    v_pk_mul_f32 v[6:7], v[122:123], v[250:251]
    v_pk_mul_f32 v[8:9], v[126:127], v[250:251]
    v_pk_fma_f32 v[6:7], v[126:127], v[254:255], v[6:7]
    v_pk_fma_f32 v[8:9], v[122:123], v[254:255], v[8:9] neg_lo:[1,0,0] neg_hi:[1,0,0]
    v_cvt_pk_bf16_f32 v134, v6, v8
    v_cvt_pk_bf16_f32 v135, v7, v9
    ds_write_b128 v11, v[132:135] offset:57344
    v_mov_b32 v2, 163732
    v_mov_b32 v3, 1
    s_mov_b64 exec, 1
    ds_add_u32 v2, v3
    s_mov_b64 exec, -1
    s_mov_b32 s62, 1048576
SR_65:
    ds_read_b32 v3, v2
    ds_read_b128 v[64:67], v14 offset:53248
    ds_read_b128 v[68:71], v14 offset:54272
    ds_read_b128 v[72:75], v14 offset:55296
    ds_read_b128 v[76:79], v14 offset:56320
    ds_read_b128 v[80:83], v14 offset:57344
    ds_read_b128 v[84:87], v14 offset:58368
    ds_read_b128 v[88:91], v14 offset:59392
    ds_read_b128 v[92:95], v14 offset:60416
    s_sub_u32 s62, s62, 1
    s_waitcnt lgkmcnt(8)
    v_cmp_gt_u32 vcc, 4, v3
    s_nop 0
    s_cselect_b64 vcc, 0, vcc
    s_cbranch_vccnz SR_65
    v_and_b32 v5, 15, v0
    v_lshrrev_b32 v6, 4, v0
    v_lshlrev_b32 v11, 4, v5
    v_lshl_add_u32 v11, v6, 9, v11
    s_lshl_b32 s60, s44, 13
    s_lshl_b32 s61, s3, 11
    s_lshl_b32 s62, s44, 7
    s_add_u32 s61, s61, s62
    v_add_u32 v11, s61, v11
    v_add_u32 v12, 0x100, v11
    v_and_b32 v11, 0x1fff, v11
    v_and_b32 v12, 0x1fff, v12
    s_add_u32 s60, s60, 10485760
    s_waitcnt lgkmcnt(4)
    v_mfma_f32_16x16x32_bf16 v[112:115], v[160:163], v[64:67], 0
    s_nop 4
    v_mfma_f32_16x16x32_bf16 v[116:119], v[164:167], v[64:67], 0
    s_nop 4
    v_mfma_f32_16x16x32_bf16 v[112:115], v[168:171], v[68:71], v[112:115]
    s_nop 4
    v_mfma_f32_16x16x32_bf16 v[116:119], v[172:175], v[68:71], v[116:119]
    s_nop 4
    v_mfma_f32_16x16x32_bf16 v[112:115], v[176:179], v[72:75], v[112:115]
    s_nop 4
    v_mfma_f32_16x16x32_bf16 v[116:119], v[180:183], v[72:75], v[116:119]
    s_nop 4
    v_mfma_f32_16x16x32_bf16 v[112:115], v[184:187], v[76:79], v[112:115]
    s_nop 4
    v_mfma_f32_16x16x32_bf16 v[116:119], v[188:191], v[76:79], v[116:119]
    s_nop 4
    s_waitcnt lgkmcnt(0)
    v_mfma_f32_16x16x32_bf16 v[120:123], v[160:163], v[80:83], 0
    s_nop 4
    v_mfma_f32_16x16x32_bf16 v[124:127], v[164:167], v[80:83], 0
    s_nop 4
    v_mfma_f32_16x16x32_bf16 v[120:123], v[168:171], v[84:87], v[120:123]
    s_nop 4
    v_mfma_f32_16x16x32_bf16 v[124:127], v[172:175], v[84:87], v[124:127]
    s_nop 4
    v_mfma_f32_16x16x32_bf16 v[120:123], v[176:179], v[88:91], v[120:123]
    s_nop 4
    v_mfma_f32_16x16x32_bf16 v[124:127], v[180:183], v[88:91], v[124:127]
    s_nop 4
    v_mfma_f32_16x16x32_bf16 v[120:123], v[184:187], v[92:95], v[120:123]
    s_nop 4
    v_mfma_f32_16x16x32_bf16 v[124:127], v[188:191], v[92:95], v[124:127]
    s_nop 4
    v_cvt_pk_bf16_f32 v128, v116, v112
    v_cvt_pk_bf16_f32 v129, v117, v113
    v_cvt_pk_bf16_f32 v130, v118, v114
    v_cvt_pk_bf16_f32 v131, v119, v115
    buffer_store_dwordx4 v[128:131], v11, s[4:7], s60 offen sc1
    v_cvt_pk_bf16_f32 v132, v124, v120
    v_cvt_pk_bf16_f32 v133, v125, v121
    v_cvt_pk_bf16_f32 v134, v126, v122
    v_cvt_pk_bf16_f32 v135, v127, v123
    buffer_store_dwordx4 v[132:135], v12, s[4:7], s60 offen sc1
    v_lshrrev_b32 v2, 2, v0
    v_lshlrev_b32 v2, 10, v2
    v_and_b32 v9, 3, v0
    v_lshl_add_u32 v2, v9, 4, v2
    v_mov_b32 v4, s0
    v_mov_b32 v5, s0
    v_mov_b32 v6, s0
    v_mov_b32 v7, s0
    v_mov_b32 v9, 163736
    v_mov_b32 v3, 1
    s_lshr_b32 s60, s2, 4
    s_lshl_b32 s60, s60, 14
    s_and_b32 s61, s2, 15
    s_lshl_b32 s61, s61, 2
    s_add_u32 s60, s60, s61
    s_add_u32 s60, s60, 16252928
    s_lshl_b32 s61, s2, 2
    s_add_u32 s61, s61, 16515072
    s_mov_b64 exec, 1
    s_waitcnt vmcnt(0)
    ds_add_rtn_u32 v8, v9, v3
    s_mov_b64 exec, -1
    s_waitcnt lgkmcnt(0)
    v_readfirstlane_b32 s62, v8
    s_nop 0
    s_cmp_lg_u32 s62, 3
    s_cbranch_scc1 LS_sk_66
    s_mov_b64 exec, 1
    buffer_atomic_swap v4, v2, s[4:7], s61 offen sc1
    s_mov_b32 exec_lo, 0x11111111
    s_mov_b32 exec_hi, 0x11111111
    buffer_atomic_swap v4, v2, s[4:7], s60 offen sc1
    s_mov_b64 exec, -1
LS_sk_66:
    s_cmp_lt_u32 s3, 2
    s_cbranch_scc1 K_01_67
    v_lshrrev_b32 v4, 1, v0
    v_and_b32 v3, 1, v0
    v_lshlrev_b32 v3, 4, v3
    v_lshl_add_u32 v3, v4, 13, v3
    s_lshl_b32 s60, s44, 5
    s_movk_i32 s63, 0x1fff
    v_lshl_add_u32 v4, v4, 7, s60
    v_and_or_b32 v12, v4, s63, v3
    v_add_u32 v4, 4096, v4
    v_and_or_b32 v13, v4, s63, v3
    s_lshr_b32 s60, 4, s3
    s_bitcmp1_b32 s60, 0
    s_cbranch_scc0 K_e_68
    s_lshl_b32 s61, s2, 10
    s_add_u32 s61, s61, 16252928
    v_lshlrev_b32 v2, 2, v0
    s_mov_b64 exec, 0xffff
    s_mov_b32 s62, 65536
P_70:
    v_mov_b32 v3, 0
    buffer_atomic_or v3, v2, s[4:7], s61 offen sc0 sc1
    s_waitcnt vmcnt(0)
    v_cmp_ne_u32 vcc, s0, v3
    s_sub_u32 s62, s62, 1
    s_cselect_b64 vcc, 0, vcc
    s_cbranch_vccz P_71
    s_setprio 0
    s_mov_b32 s63, 0
PS_72:
    s_nop 15
    s_nop 15
    s_sub_u32 s63, s63, 1
    s_cbranch_scc0 PS_72
    s_setprio 3
    s_branch P_70
P_71:
    s_mov_b64 exec, -1
    s_mov_b32 s62, 65536
WA_73:
    v_lshlrev_b32 v2, 4, v0
    s_mov_b32 s60, 16515072
    buffer_load_dwordx4 v[4:7], v2, s[4:7], s60 offen sc1
    s_waitcnt vmcnt(0)
WA_76:
    v_xor_b32 v4, s0, v4
    v_xor_b32 v5, s0, v5
    v_xor_b32 v6, s0, v6
    v_xor_b32 v7, s0, v7
    v_or3_b32 v4, v4, v5, v6
    v_or_b32 v4, v4, v7
    v_cmp_ne_u32 vcc, 0, v4
    s_cbranch_vccz WA_74
    s_setprio 0
    s_mov_b64 exec, vcc
    s_bcnt1_i32_b64 s63, vcc
    s_lshr_b32 s63, s63, 1
    s_add_u32 s63, s63, 6
    s_sub_u32 s62, s62, 1
    s_cbranch_scc1 WA_74
WA_75:
    s_nop 15
    s_sub_u32 s63, s63, 1
    s_cbranch_scc0 WA_75
    s_setprio 3
    s_branch WA_73
WA_74:
    s_mov_b64 exec, -1
    s_setprio 3
    v_mov_b32 v2, 163756
    v_mov_b32 v3, 17825792
    s_mov_b64 exec, 1
    ds_add_u32 v2, v3
    s_mov_b64 exec, -1
    s_branch K_e_69
K_e_68:
    v_mov_b32 v2, 163756
    s_mov_b32 s62, 1048576
    s_branch CS_78
CS_77:
    s_nop 15
    s_nop 15
    s_nop 15
    s_nop 15
    s_nop 15
CS_78:
    ds_read_b32 v3, v2
    s_waitcnt lgkmcnt(0)
    v_cmp_gt_u32 vcc, 1, v3
    s_sub_u32 s62, s62, 1
    s_cselect_b64 vcc, 0, vcc
    s_cbranch_vccnz CS_77
K_e_69:
    s_and_b32 s61, s3, 1
    s_lshl_b32 s60, s61, 20
    s_lshl_b32 s62, s61, 12
    s_add_u32 m0, s62, 36864
    s_add_u32 s63, s60, 10485760
    buffer_load_dwordx4 v12, s[4:7], s63 offen sc1 lds
    s_add_u32 m0, s62, 37888
    s_add_u32 s63, s60, 10747904
    buffer_load_dwordx4 v13, s[4:7], s63 offen sc1 lds
    s_add_u32 m0, s62, 38912
    s_add_u32 s63, s60, 11010048
    buffer_load_dwordx4 v12, s[4:7], s63 offen sc1 lds
    s_add_u32 m0, s62, 39936
    s_add_u32 s63, s60, 11272192
    buffer_load_dwordx4 v13, s[4:7], s63 offen sc1 lds
    s_setprio 0
    v_and_b32 v2, 31, v0
    v_lshrrev_b32 v3, 5, v0
    v_lshl_add_u32 v4, v3, 7, v2
    v_lshlrev_b32 v4, 5, v4
    s_lshl_b32 s61, s61, 4
    v_add_u32 v4, s61, v4
    v_mov_b32 v6, 0x2000
    v_cmp_eq_u32 vcc, 32, v0
    s_nop 1
    v_cndmask_b32 v8, v4, v6, vcc
    s_add_u32 s61, s61, 0x1000
    v_mov_b32 v7, s61
    v_cmp_eq_u32 vcc, 0, v0
    s_nop 1
    v_cndmask_b32 v9, v8, v7, vcc
    v_cmp_gt_u32 vcc, 32, v0
    s_nop 1
    v_cndmask_b32 v10, v6, v8, vcc
    v_cndmask_b32 v11, v6, v9, vcc
    v_mov_b32 v64, 0
    v_mov_b32 v65, 0
    v_mov_b32 v66, 0
    v_mov_b32 v67, 0
    v_and_b32 v5, 3, v0
    v_lshlrev_b32 v5, 10, v5
    ds_write_b128 v5, v[64:67] offset:45056
    v_and_b32 v2, 31, v0
    v_lshrrev_b32 v3, 5, v0
    v_mul_u32_u24 v4, 7, v2
    v_lshl_add_u32 v4, v3, 8, v4
    s_and_b32 s65, s3, 1
    s_mul_i32 s64, s65, 3584
    s_add_u32 s64, s64, 53248
    v_add_u32 v6, 0, v4
    v_subrev_u32 v7, 0x1c0, v6
    v_min_u32 v6, v6, v7
    v_lshl_add_u32 v224, v6, 1, s64
    v_add_u32 v6, 64, v4
    v_subrev_u32 v7, 0x1c0, v6
    v_min_u32 v6, v6, v7
    v_lshl_add_u32 v225, v6, 1, s64
    v_add_u32 v6, 128, v4
    v_subrev_u32 v7, 0x1c0, v6
    v_min_u32 v6, v6, v7
    v_lshl_add_u32 v226, v6, 1, s64
    v_add_u32 v6, 192, v4
    v_subrev_u32 v7, 0x1c0, v6
    v_min_u32 v6, v6, v7
    v_lshl_add_u32 v227, v6, 1, s64
    v_add_u32 v6, 224, v4
    v_subrev_u32 v7, 0x1c0, v6
    v_min_u32 v6, v6, v7
    v_lshl_add_u32 v228, v6, 1, s64
    v_add_u32 v6, 288, v4
    v_subrev_u32 v7, 0x1c0, v6
    v_min_u32 v6, v6, v7
    v_lshl_add_u32 v229, v6, 1, s64
    v_add_u32 v6, 352, v4
    v_subrev_u32 v7, 0x1c0, v6
    v_min_u32 v6, v6, v7
    v_lshl_add_u32 v230, v6, 1, s64
    v_add_u32 v6, 416, v4
    v_subrev_u32 v7, 0x1c0, v6
    v_min_u32 v6, v6, v7
    v_lshl_add_u32 v231, v6, 1, s64
    v_mov_b32 v6, 60416
    v_cmp_gt_u32 vcc, 32, v0
    s_nop 1
    v_cndmask_b32 v227, v6, v227, vcc
    v_cndmask_b32 v231, v6, v231, vcc
    v_lshlrev_b32 v5, 4, v0
    v_add_u32 v6, s64, v5
    s_lshr_b32 s72, s44, 4
    s_lshl_b32 s72, s72, 7
    s_and_b32 s73, s44, 15
    s_lshl_b32 s73, s73, 1
    s_add_u32 s72, s72, s73
    s_add_u32 s72, s72, s65
    s_mul_i32 s72, s72, 1792
    s_waitcnt vmcnt(0)
    v_mov_b32 v2, 163772
    v_mov_b32 v3, 1
    s_mov_b64 exec, 1
    ds_add_u32 v2, v3
    s_mov_b64 exec, -1
    s_mov_b32 s62, 1048576
SR_79:
    ds_read_b32 v3, v2
    ds_read_b128 v[64:67], v8 offset:36864
    ds_read_b128 v[68:71], v9 offset:36864
    ds_read_b128 v[72:75], v8 offset:37888
    ds_read_b128 v[76:79], v9 offset:37888
    ds_read_b128 v[80:83], v8 offset:38912
    ds_read_b128 v[84:87], v9 offset:38912
    ds_read_b128 v[88:91], v10 offset:39936
    ds_read_b128 v[92:95], v11 offset:39936
    s_sub_u32 s62, s62, 1
    s_waitcnt lgkmcnt(8)
    v_cmp_gt_u32 vcc, 2, v3
    s_nop 0
    s_cselect_b64 vcc, 0, vcc
    s_cbranch_vccnz SR_79
    s_waitcnt lgkmcnt(6)
    v_mfma_f32_32x32x16_bf16 v[160:175], v[64:67], v[32:35], 0
    v_mfma_f32_32x32x16_bf16 v[176:191], v[68:71], v[36:39], 0
    s_waitcnt lgkmcnt(4)
    v_mfma_f32_32x32x16_bf16 v[160:175], v[72:75], v[40:43], v[160:175]
    v_mfma_f32_32x32x16_bf16 v[176:191], v[76:79], v[44:47], v[176:191]
    s_waitcnt lgkmcnt(2)
    v_mfma_f32_32x32x16_bf16 v[160:175], v[80:83], v[48:51], v[160:175]
    v_mfma_f32_32x32x16_bf16 v[176:191], v[84:87], v[52:55], v[176:191]
    s_waitcnt lgkmcnt(0)
    v_mfma_f32_32x32x16_bf16 v[160:175], v[88:91], v[56:59], v[160:175]
    v_mfma_f32_32x32x16_bf16 v[176:191], v[92:95], v[60:63], v[176:191]
    s_nop 11
    v_cvt_pk_bf16_f32 v64, v160, v176
    v_cvt_pk_bf16_f32 v65, v161, v177
    v_cvt_pk_bf16_f32 v66, v162, v178
    v_cvt_pk_bf16_f32 v67, v163, v179
    s_nop 1
    v_mfma_f32_32x32x16_bf16 v[192:207], v[64:67], v[96:99], 0
    v_mfma_f32_32x32x16_bf16 v[208:223], v[64:67], v[144:147], 0
    v_cvt_pk_bf16_f32 v68, v164, v180
    v_cvt_pk_bf16_f32 v69, v165, v181
    v_cvt_pk_bf16_f32 v70, v166, v182
    v_cvt_pk_bf16_f32 v71, v167, v183
    s_nop 1
    v_mfma_f32_32x32x16_bf16 v[192:207], v[68:71], v[100:103], v[192:207]
    v_mfma_f32_32x32x16_bf16 v[208:223], v[68:71], v[148:151], v[208:223]
    v_cvt_pk_bf16_f32 v72, v168, v184
    v_cvt_pk_bf16_f32 v73, v169, v185
    v_cvt_pk_bf16_f32 v74, v170, v186
    v_cvt_pk_bf16_f32 v75, v171, v187
    s_nop 1
    v_mfma_f32_32x32x16_bf16 v[192:207], v[72:75], v[104:107], v[192:207]
    v_mfma_f32_32x32x16_bf16 v[208:223], v[72:75], v[152:155], v[208:223]
    v_cvt_pk_bf16_f32 v76, v172, v188
    v_cvt_pk_bf16_f32 v77, v173, v189
    v_cvt_pk_bf16_f32 v78, v174, v190
    v_cvt_pk_bf16_f32 v79, v175, v191
    s_nop 1
    v_mfma_f32_32x32x16_bf16 v[192:207], v[76:79], v[108:111], v[192:207]
    v_mfma_f32_32x32x16_bf16 v[208:223], v[76:79], v[156:159], v[208:223]
    s_nop 10
    v_cvt_pk_bf16_f32 v232, v192, v196
    ds_write_b16 v224, v232 offset:0
    ds_write_b16_d16_hi v224, v232 offset:896
    v_cvt_pk_bf16_f32 v233, v193, v197
    ds_write_b16 v225, v233 offset:0
    ds_write_b16_d16_hi v225, v233 offset:896
    v_cvt_pk_bf16_f32 v234, v194, v198
    ds_write_b16 v226, v234 offset:0
    ds_write_b16_d16_hi v226, v234 offset:896
    v_cvt_pk_bf16_f32 v235, v195, v199
    ds_write_b16 v227, v235 offset:0
    ds_write_b16_d16_hi v227, v235 offset:896
    v_cvt_pk_bf16_f32 v236, v200, v204
    ds_write_b16 v224, v236 offset:1792
    ds_write_b16_d16_hi v224, v236 offset:2688
    v_cvt_pk_bf16_f32 v237, v201, v205
    ds_write_b16 v225, v237 offset:1792
    ds_write_b16_d16_hi v225, v237 offset:2688
    v_cvt_pk_bf16_f32 v238, v202, v206
    ds_write_b16 v226, v238 offset:1792
    ds_write_b16_d16_hi v226, v238 offset:2688
    v_cvt_pk_bf16_f32 v239, v203, v207
    ds_write_b16 v227, v239 offset:1792
    ds_write_b16_d16_hi v227, v239 offset:2688
    v_cvt_pk_bf16_f32 v240, v208, v212
    ds_write_b16 v228, v240 offset:0
    ds_write_b16_d16_hi v228, v240 offset:896
    v_cvt_pk_bf16_f32 v241, v209, v213
    ds_write_b16 v229, v241 offset:0
    ds_write_b16_d16_hi v229, v241 offset:896
    v_cvt_pk_bf16_f32 v242, v210, v214
    ds_write_b16 v230, v242 offset:0
    ds_write_b16_d16_hi v230, v242 offset:896
    v_cvt_pk_bf16_f32 v243, v211, v215
    ds_write_b16 v231, v243 offset:0
    ds_write_b16_d16_hi v231, v243 offset:896
    v_cvt_pk_bf16_f32 v244, v216, v220
    ds_write_b16 v228, v244 offset:1792
    ds_write_b16_d16_hi v228, v244 offset:2688
    v_cvt_pk_bf16_f32 v245, v217, v221
    ds_write_b16 v229, v245 offset:1792
    ds_write_b16_d16_hi v229, v245 offset:2688
    v_cvt_pk_bf16_f32 v246, v218, v222
    ds_write_b16 v230, v246 offset:1792
    ds_write_b16_d16_hi v230, v246 offset:2688
    v_cvt_pk_bf16_f32 v247, v219, v223
    ds_write_b16 v231, v247 offset:1792
    ds_write_b16_d16_hi v231, v247 offset:2688
    ds_read_b128 v[160:163], v6 offset:0
    ds_read_b128 v[164:167], v6 offset:896
    ds_read_b128 v[168:171], v6 offset:1792
    ds_read_b128 v[172:175], v6 offset:2688
    s_mov_b32 exec_hi, 0x00ffffff
    s_waitcnt lgkmcnt(3)
    s_add_u32 s73, s72, 0
    buffer_store_dwordx4 v[160:163], v5, s[32:35], s73 offen sc1
    s_waitcnt lgkmcnt(2)
    s_add_u32 s73, s72, 57344
    buffer_store_dwordx4 v[164:167], v5, s[32:35], s73 offen sc1
    s_waitcnt lgkmcnt(1)
    s_add_u32 s73, s72, 114688
    buffer_store_dwordx4 v[168:171], v5, s[32:35], s73 offen sc1
    s_waitcnt lgkmcnt(0)
    s_add_u32 s73, s72, 172032
    buffer_store_dwordx4 v[172:175], v5, s[32:35], s73 offen sc1
    s_mov_b64 exec, -1
    s_endpgm
K_01_67:
NOA_01:
    v_and_b32 v8, 7, v0
    v_lshlrev_b32 v8, 2, v8
    s_lshl_b32 s66, s48, 2
    s_add_u32 s66, s66, s49
    s_lshl_b32 s66, s66, 11
    s_lshl_b32 s67, s3, 9
    s_add_u32 s66, s66, s67
    s_add_u32 s66, s66, 13107200
    s_lshl_b32 s68, s3, 14
    s_lshl_b32 s67, s48, 15
    s_add_u32 s67, s67, s68
    s_add_u32 s67, s67, 4194304
    v_add_u32 v9, s68, v14
    s_and_b32 s69, s0, 0x9fff
    s_or_b32 s69, s69, 0x2000
    s_lshl_b32 s70, s3, 3
    s_add_u32 s70, s70, 163792
    v_mov_b32 v10, s70
    s_lshl_b32 s70, s3, 1
    s_lshl_b32 s70, 1, s70
    v_mov_b32 v11, s70
    v_lshlrev_b32 v12, 1, v11
    s_mov_b32 s71, 3
    v_mov_b32 v2, 163724
    s_mov_b32 s62, 1048576
    s_branch CS_83
CS_82:
    s_nop 15
    s_nop 15
    s_nop 15
    s_nop 15
    s_nop 15
CS_83:
    ds_read_b32 v3, v2
    s_waitcnt lgkmcnt(0)
    v_cmp_gt_u32 vcc, 4, v3
    s_sub_u32 s62, s62, 1
    s_cselect_b64 vcc, 0, vcc
    s_cbranch_vccnz CS_82
    v_mov_b32 v13, 0
    s_movk_i32 s74, 0xff
    s_mov_b32 s75, 0
    s_mov_b32 exec_hi, 0
    s_mov_b32 exec_lo, s74
    v_mov_b32 v13, 0
    buffer_atomic_or v13, v8, s[4:7], s66 offen sc0 sc1
    s_mov_b32 exec_lo, -1
    s_lshl_b32 s74, s74, 8
    s_and_b32 s74, s74, 255
    s_cselect_b32 s74, s74, 0xff
    v_mov_b32 v2, 163740
    s_mov_b32 s62, 1048576
    s_branch CS_85
CS_84:
    s_nop 15
    s_nop 15
    s_nop 15
    s_nop 15
    s_nop 15
CS_85:
    ds_read_b32 v3, v2
    s_waitcnt lgkmcnt(0)
    v_cmp_gt_u32 vcc, 4, v3
    s_sub_u32 s62, s62, 1
    s_cselect_b64 vcc, 0, vcc
    s_cbranch_vccnz CS_84
    s_mov_b32 s72, 65536
OF_80:
    s_waitcnt vmcnt(0)
    v_cmp_eq_u32 vcc, s0, v13
    s_sub_u32 s72, s72, 1
    s_cselect_b32 s73, 0, -1
    s_cselect_b32 s72, 0, s72
    s_or_b32 s75, s75, vcc_lo
    s_andn2_b32 s61, s73, s75
    s_and_b32 s60, s61, 15
    s_cselect_b32 s60, 0, 1
    s_and_b32 s61, s61, 0xf0
    s_cselect_b32 s61, 0, 2
    s_or_b32 s60, s60, s61
    s_and_b32 s60, s60, s71
    s_cbranch_scc1 OF_81
    s_mov_b32 exec_lo, s74
    v_mov_b32 v13, 0
    buffer_atomic_or v13, v8, s[4:7], s66 offen sc0 sc1
    s_mov_b32 exec_lo, -1
    s_lshl_b32 s74, s74, 8
    s_and_b32 s74, s74, 255
    s_cselect_b32 s74, s74, 0xff
    s_branch OF_80
OF_81:
    s_mov_b32 exec_hi, -1
    s_bitcmp1_b32 s60, 0
    s_cbranch_scc0 OF_86
    s_add_u32 m0, s68, 0
    s_add_u32 s61, s67, 0
    buffer_load_dwordx4 v14, s[4:7], s61 offen offset:0 sc1 lds
    buffer_load_dwordx4 v14, s[4:7], s61 offen offset:1024 sc1 lds
    buffer_load_dwordx4 v14, s[4:7], s61 offen offset:2048 sc1 lds
    buffer_load_dwordx4 v14, s[4:7], s61 offen offset:3072 sc1 lds
    s_add_u32 m0, s68, 4096
    s_add_u32 s61, s67, 4096
    buffer_load_dwordx4 v14, s[4:7], s61 offen offset:0 sc1 lds
    buffer_load_dwordx4 v14, s[4:7], s61 offen offset:1024 sc1 lds
    buffer_load_dwordx4 v14, s[4:7], s61 offen offset:2048 sc1 lds
    buffer_load_dwordx4 v14, s[4:7], s61 offen offset:3072 sc1 lds
OF_86:
    s_bitcmp1_b32 s60, 1
    s_cbranch_scc0 OF_87
    s_add_u32 m0, s68, 8192
    s_add_u32 s61, s67, 8192
    buffer_load_dwordx4 v14, s[4:7], s61 offen offset:0 sc1 lds
    buffer_load_dwordx4 v14, s[4:7], s61 offen offset:1024 sc1 lds
    buffer_load_dwordx4 v14, s[4:7], s61 offen offset:2048 sc1 lds
    buffer_load_dwordx4 v14, s[4:7], s61 offen offset:3072 sc1 lds
    s_add_u32 m0, s68, 12288
    s_add_u32 s61, s67, 12288
    buffer_load_dwordx4 v14, s[4:7], s61 offen offset:0 sc1 lds
    buffer_load_dwordx4 v14, s[4:7], s61 offen offset:1024 sc1 lds
    buffer_load_dwordx4 v14, s[4:7], s61 offen offset:2048 sc1 lds
    buffer_load_dwordx4 v14, s[4:7], s61 offen offset:3072 sc1 lds
OF_87:
    s_cmp_eq_u32 s60, s71
    s_cbranch_scc1 OF_88
    s_waitcnt vmcnt(8)
    s_mov_b32 exec_hi, 0
    s_mov_b32 exec_lo, s74
    v_mov_b32 v13, 0
    buffer_atomic_or v13, v8, s[4:7], s66 offen sc0 sc1
    s_mov_b32 exec_lo, -1
    s_lshl_b32 s74, s74, 8
    s_and_b32 s74, s74, 255
    s_cselect_b32 s74, s74, 0xff
    s_mov_b32 exec_hi, -1
    s_waitcnt vmcnt(1)
    s_branch OF_89
OF_88:
    s_waitcnt vmcnt(0)
OF_89:
    s_bitcmp1_b32 s60, 0
    s_cbranch_scc0 OF_90
    ds_read_u16 v16, v9 offset:14
    ds_read_u16 v17, v9 offset:1038
    ds_read_u16 v18, v9 offset:2062
    ds_read_u16 v19, v9 offset:3086
    ds_read_u16 v20, v9 offset:4110
    ds_read_u16 v21, v9 offset:5134
    ds_read_u16 v22, v9 offset:6158
    ds_read_u16 v23, v9 offset:7182
    s_waitcnt lgkmcnt(4)
    v_sad_u32 v24, v16, s69, 0
    v_sad_u32 v24, v17, s69, v24
    v_sad_u32 v24, v18, s69, v24
    v_sad_u32 v24, v19, s69, v24
    s_waitcnt lgkmcnt(0)
    v_sad_u32 v24, v20, s69, v24
    v_sad_u32 v24, v21, s69, v24
    v_sad_u32 v24, v22, s69, v24
    v_sad_u32 v24, v23, s69, v24
    v_and_b32 v24, s73, v24
    v_cmp_ne_u32 vcc, 0, v24
    s_cbranch_vccnz OF_90
    ds_write_b32 v10, v11 offset:0
    s_bitset0_b32 s71, 0
OF_90:
    s_bitcmp1_b32 s60, 1
    s_cbranch_scc0 OF_91
    ds_read_u16 v16, v9 offset:8206
    ds_read_u16 v17, v9 offset:9230
    ds_read_u16 v18, v9 offset:10254
    ds_read_u16 v19, v9 offset:11278
    ds_read_u16 v20, v9 offset:12302
    ds_read_u16 v21, v9 offset:13326
    ds_read_u16 v22, v9 offset:14350
    ds_read_u16 v23, v9 offset:15374
    s_waitcnt lgkmcnt(4)
    v_sad_u32 v24, v16, s69, 0
    v_sad_u32 v24, v17, s69, v24
    v_sad_u32 v24, v18, s69, v24
    v_sad_u32 v24, v19, s69, v24
    s_waitcnt lgkmcnt(0)
    v_sad_u32 v24, v20, s69, v24
    v_sad_u32 v24, v21, s69, v24
    v_sad_u32 v24, v22, s69, v24
    v_sad_u32 v24, v23, s69, v24
    v_and_b32 v24, s73, v24
    v_cmp_ne_u32 vcc, 0, v24
    s_cbranch_vccnz OF_91
    ds_write_b32 v10, v12 offset:4
    s_bitset0_b32 s71, 1
OF_91:
    s_cmp_lg_u32 s71, 0
    s_cselect_b32 exec_hi, 0, -1
    s_cbranch_scc1 OF_80
K_end_1:
    s_waitcnt vmcnt(0) lgkmcnt(0)
    s_endpgm
K_slow_20:
    s_lshl_b32 s60, s41, 18
    v_mov_b32 v9, 0xff800000
    s_mov_b32 s61, 0
SL1_92:
    s_and_b32 s62, s61, 0xffffe000
    s_add_u32 s62, s62, s61
    s_add_u32 s62, s62, s60
    buffer_load_dwordx4 v[152:155], v14, s[4:7], s62 offen sc1
    buffer_load_dwordx4 v[156:159], v14, s[4:7], s62 offen offset:1024 sc1
    s_waitcnt vmcnt(0)
    v_mfma_f32_32x32x16_bf16 v[112:127], v[152:155], v[40:43], 0
    v_mfma_f32_32x32x16_bf16 v[112:127], v[156:159], v[44:47], v[112:127]
    s_nop 11
    v_max3_f32 v9, v9, v112, v113
    v_max3_f32 v9, v9, v114, v115
    v_max3_f32 v9, v9, v116, v117
    v_max3_f32 v9, v9, v118, v119
    v_max3_f32 v9, v9, v120, v121
    v_max3_f32 v9, v9, v122, v123
    v_max3_f32 v9, v9, v124, v125
    v_max3_f32 v9, v9, v126, v127
    s_add_u32 s61, s61, 2048
    s_cmp_lt_u32 s61, 131072
    s_cbranch_scc1 SL1_92
    v_mov_b32 v10, v9
    s_nop 1
    v_permlane32_swap_b32 v9, v10
    v_max_f32 v9, v9, v10
    v_mov_b32 v96, 0
    v_mov_b32 v97, 0
    v_mov_b32 v98, 0
    v_mov_b32 v99, 0
    v_mov_b32 v100, 0
    v_mov_b32 v101, 0
    v_mov_b32 v102, 0
    v_mov_b32 v103, 0
    v_mov_b32 v104, 0
    v_mov_b32 v105, 0
    v_mov_b32 v106, 0
    v_mov_b32 v107, 0
    v_mov_b32 v108, 0
    v_mov_b32 v109, 0
    v_mov_b32 v110, 0
    v_mov_b32 v111, 0
    s_mov_b32 s61, 0
SL2_93:
    s_and_b32 s62, s61, 0xffffe000
    s_add_u32 s62, s62, s61
    s_add_u32 s62, s62, s60
    buffer_load_dwordx4 v[152:155], v14, s[4:7], s62 offen sc1
    buffer_load_dwordx4 v[156:159], v14, s[4:7], s62 offen offset:1024 sc1
    buffer_load_dwordx4 v[184:187], v219, s[4:7], s62 offen sc1
    buffer_load_dwordx4 v[188:191], v219, s[4:7], s62 offen offset:1024 sc1
    s_waitcnt vmcnt(0)
    v_mfma_f32_32x32x16_bf16 v[112:127], v[152:155], v[40:43], 0
    v_mfma_f32_32x32x16_bf16 v[112:127], v[156:159], v[44:47], v[112:127]
    s_nop 11
    v_sub_f32 v112, v112, v9
    v_sub_f32 v113, v113, v9
    v_sub_f32 v114, v114, v9
    v_sub_f32 v115, v115, v9
    v_sub_f32 v116, v116, v9
    v_sub_f32 v117, v117, v9
    v_sub_f32 v118, v118, v9
    v_sub_f32 v119, v119, v9
    v_sub_f32 v120, v120, v9
    v_sub_f32 v121, v121, v9
    v_sub_f32 v122, v122, v9
    v_sub_f32 v123, v123, v9
    v_sub_f32 v124, v124, v9
    v_sub_f32 v125, v125, v9
    v_sub_f32 v126, v126, v9
    v_sub_f32 v127, v127, v9
    v_exp_f32 v112, v112
    v_exp_f32 v113, v113
    v_exp_f32 v114, v114
    v_exp_f32 v115, v115
    v_exp_f32 v116, v116
    v_exp_f32 v117, v117
    v_exp_f32 v118, v118
    v_exp_f32 v119, v119
    v_exp_f32 v120, v120
    v_exp_f32 v121, v121
    v_exp_f32 v122, v122
    v_exp_f32 v123, v123
    v_exp_f32 v124, v124
    v_exp_f32 v125, v125
    v_exp_f32 v126, v126
    v_exp_f32 v127, v127
    v_cvt_pk_bf16_f32 v144, v112, v113
    v_cvt_pk_bf16_f32 v145, v114, v115
    v_cvt_pk_bf16_f32 v146, v116, v117
    v_cvt_pk_bf16_f32 v147, v118, v119
    v_cvt_pk_bf16_f32 v148, v120, v121
    v_cvt_pk_bf16_f32 v149, v122, v123
    v_cvt_pk_bf16_f32 v150, v124, v125
    v_cvt_pk_bf16_f32 v151, v126, v127
    v_mfma_f32_32x32x16_bf16 v[96:111], v[184:187], v[144:147], v[96:111]
    s_nop 0
    v_mfma_f32_32x32x16_bf16 v[96:111], v[188:191], v[148:151], v[96:111]
    s_add_u32 s61, s61, 2048
    s_cmp_lt_u32 s61, 131072
    s_cbranch_scc1 SL2_93
    s_nop 8
    v_mov_b32 v9, v103
    s_mov_b32 s82, 0
    s_branch K_sret_21
PW_17:
    v_mov_b32 v2, 163716
    s_mov_b32 s62, 1048576
CS_94:
    ds_read_b32 v3, v2
    s_waitcnt lgkmcnt(0)
    v_cmp_gt_u32 vcc, 4, v3
    s_sub_u32 s62, s62, 1
    s_cselect_b64 vcc, 0, vcc
    s_cbranch_vccnz CS_94
    s_branch PW_18
WD_fb:
    s_mov_b32 s82, 17825792
    s_sub_u32 s52, s73, 65536
    buffer_load_dwordx4 v[152:155], v14, s[80:83], s52 offen offset:0 sc1
    buffer_load_dwordx4 v[156:159], v14, s[80:83], s52 offen offset:1024 sc1
    buffer_load_dwordx4 v[184:187], v219, s[80:83], s52 offen offset:0 sc1
    buffer_load_dwordx4 v[188:191], v219, s[80:83], s52 offen offset:1024 sc1
    buffer_load_dwordx4 v[160:163], v14, s[80:83], s52 offen offset:2048 sc1
    buffer_load_dwordx4 v[164:167], v14, s[80:83], s52 offen offset:3072 sc1
    buffer_load_dwordx4 v[192:195], v219, s[80:83], s52 offen offset:2048 sc1
    buffer_load_dwordx4 v[196:199], v219, s[80:83], s52 offen offset:3072 sc1
    buffer_load_dwordx4 v[168:171], v218, s[80:83], s52 offen offset:0 sc1
    buffer_load_dwordx4 v[172:175], v218, s[80:83], s52 offen offset:1024 sc1
    buffer_load_dwordx4 v[200:203], v220, s[80:83], s52 offen offset:0 sc1
    buffer_load_dwordx4 v[204:207], v220, s[80:83], s52 offen offset:1024 sc1
    buffer_load_dwordx4 v[176:179], v218, s[80:83], s52 offen offset:2048 sc1
    buffer_load_dwordx4 v[180:183], v218, s[80:83], s52 offen offset:3072 sc1
    s_waitcnt vmcnt(0)
    s_branch WD_ret
    s_endpgm
.fill (30720 - (. - K_PC)) / 4, 4, 0xbf800000
.section .rodata,"a"
.p2align 6
.amdhsa_kernel concat_heads__spectral_gfnet__mha_block__prompt_kernel
  .amdhsa_next_free_vgpr 256
  .amdhsa_next_free_sgpr 102
  .amdhsa_accum_offset 256
  .amdhsa_group_segment_fixed_size 0
  .amdhsa_kernarg_size 72
  .amdhsa_user_sgpr_count 2
  .amdhsa_user_sgpr_kernarg_segment_ptr 1
  .amdhsa_system_sgpr_workgroup_id_x 1
.end_amdhsa_kernel
```
